```python
import torch

def _softmax(x, axis=-1):
    return torch.softmax(x, dim=axis)
def _gelu(x):
    return torch.nn.functional.gelu(x, approximate="tanh")
def _silu(x):
    return torch.nn.functional.silu(x)
def _sigmoid(x):
    return torch.sigmoid(x)
def _layernorm(x, axis=-1, eps=1e-5):
    m = x.mean(dim=axis, keepdim=True)
    v = x.var(dim=axis, keepdim=True, unbiased=False)
    return (x - m) / torch.sqrt(v + eps)
def _scatter_add(tgt, idx, src, axis=0):
    return tgt.clone().index_add_(axis, idx, src)
def _segment_sum(src, seg, n):
    out = torch.zeros((n,) + src.shape[1:], dtype=src.dtype)
    return out.index_add_(0, seg, src)
def _pad(x, pw):
    flat = tuple(v for pair in reversed(pw) for v in pair)
    return torch.nn.functional.pad(x, flat)

kernel_name = 'interleave_layers__sliding_block_cached__dense_activation_mish__decode'

def setup_inputs():

    _w = (lambda a: (lambda t: t.to(torch.bfloat16) if t.is_floating_point() else t)(torch.as_tensor(a)))
    def _A_setup():
        B, Sq, D = 1, 1, 576
        Hq, Hkv, Sk, Dh = 32, 16, 32768, 128
        assert Hq % Hkv == 0, (Hq, Hkv)
        return {
            "x": _w((lambda *s: torch.randn(*s, dtype=torch.bfloat16) * 0.05)(B, Sq, D)),
            "k_cache": _w((lambda *s: torch.randn(*s, dtype=torch.bfloat16) * 1.6)(B, Hkv, Sk, Dh)),
            "v_cache": _w((lambda *s: torch.randn(*s, dtype=torch.bfloat16) * 1.6)(B, Hkv, Sk, Dh)),
            "wq": _w((lambda *s: torch.randn(*s, dtype=torch.bfloat16) * 1.6)(D, Hq * Dh) * (D ** -0.5)),
            "wo": _w((lambda *s: torch.randn(*s, dtype=torch.bfloat16) * 1.6)(Hq * Dh, D) * ((Hq * Dh) ** -0.5)),
        }
    _A_in = _A_setup()

    def _B_setup():
        B, S, D, F = 1, 1, 576, 4608
        return {
            "x": _w((lambda *s: torch.randn(*s, dtype=torch.bfloat16) * 0.05)(B, S, D)),
            "w1": _w((lambda *s: torch.randn(*s, dtype=torch.bfloat16) * 0.8)(D, F) * (D ** -0.5)),
            "b1": _w((lambda *s: torch.randn(*s, dtype=torch.bfloat16) * 0.8)(F)),
            "w2": _w((lambda *s: torch.randn(*s, dtype=torch.bfloat16) * 0.8)(F, D) * (F ** -0.5)),
        }
    _B_in = _B_setup()

    return {
        "A_x": _A_in["x"],
        "A_k_cache": _A_in["k_cache"],
        "A_v_cache": _A_in["v_cache"],
        "A_wq": _A_in["wq"],
        "A_wo": _A_in["wo"],
        "B_x": _B_in["x"],
        "B_w1": _B_in["w1"],
        "B_b1": _B_in["b1"],
        "B_w2": _B_in["w2"],
    }

def reference(A_x, A_k_cache, A_v_cache, A_wq, A_wo, B_x, B_w1, B_b1, B_w2):
    def _A_ref(x, k_cache, v_cache, wq, wo):
        B, Sq, D = x.shape
        Hq, Dh = 32, 128
        Hkv, Sk = k_cache.shape[1], k_cache.shape[2]
        W = min(4096, max(256, Sk // 4))
        rep = Hq // Hkv
        q = (lambda x, *d: x.permute(*d))((x @ wq).reshape(B, Sq, Hq, Dh), 0, 2, 1, 3)
        k = (lambda x, n, axis: torch.repeat_interleave(x, n, dim=axis))(k_cache[:, :, Sk - W:, :], rep, axis=1)
        v = (lambda x, n, axis: torch.repeat_interleave(x, n, dim=axis))(v_cache[:, :, Sk - W:, :], rep, axis=1)
        scores = torch.einsum("bhqd,bhkd->bhqk", q, k) * (Dh ** -0.5)
        p = _softmax(scores, axis=-1)
        o = torch.einsum("bhqk,bhkd->bhqd", p, v)
        return (lambda x, *d: x.permute(*d))(o, 0, 2, 1, 3).reshape(B, Sq, Hq * Dh) @ wo

    def _B_ref(x, w1, b1, w2):
        h = torch.einsum("bsd,df->bsf", x, w1) + b1
        sp = torch.log1p(torch.exp(-torch.abs(h))) + torch.where(h > 0, h, torch.zeros_like(h))
        act = h * torch.tanh(sp)
        return torch.einsum("bsf,fd->bsd", act, w2)

    x = A_x
    x = x + _A_ref(_layernorm(x, axis=-1), A_k_cache, A_v_cache, A_wq, A_wo)
    x = x + _B_ref(_layernorm(x, axis=-1), B_w1, B_b1, B_w2)
    x = x + _A_ref(_layernorm(x, axis=-1), A_k_cache, A_v_cache, A_wq, A_wo)
    x = x + _B_ref(_layernorm(x, axis=-1), B_w1, B_b1, B_w2)
    return x
```

```asm
; @launch grid=(256,1,1) block=(256,1,1) lds=163840
.amdgcn_target "amdgcn-amd-amdhsa--gfx950"
.text
.globl interleave_layers__sliding_block_cached__dense_activation_mish__decode_kernel
.p2align 8
.type interleave_layers__sliding_block_cached__dense_activation_mish__decode_kernel,@function
interleave_layers__sliding_block_cached__dense_activation_mish__decode_kernel:
    s_load_dwordx16 s[32:47], s[0:1], 0
    s_load_dwordx8 s[48:55], s[0:1], 64
    s_cmp_ge_u32 s2, 256
    s_cbranch_scc1 L_end
    s_getpc_b64 s[66:67]
L_pc:
    s_lshr_b32 s5, s2, 3
    v_lshrrev_b32 v4, 6, v0
    v_lshl_add_u32 v5, s5, 2, v4
    v_lshlrev_b32 v5, 7, v5
    v_min_u32 v5, L_end-L_pc, v5
    global_load_dword v192, v5, s[66:67]
    v_readfirstlane_b32 s3, v4
    s_and_b32 s4, s2, 7
    v_and_b32 v2, 15, v0
    v_bfe_u32 v3, v0, 4, 2
    s_lshr_b32 s100, s5, 4
    s_xor_b32 s100, s100, 1
    s_lshl1_add_u32 s100, s4, s100
    s_lshl_b32 s100, s100, 7
    s_and_b32 s84, s5, 15
    s_add_u32 s100, s100, s84
    s_add_u32 s100, s100, 112
    s_lshl_b32 s100, s100, 16
    s_and_b32 s82, s5, 15
    s_lshl2_add_u32 s82, s82, s3
    s_lshl_b32 s82, s82, 10
    s_lshl_b32 s85, s3, 14
    v_xor_b32 v4, v3, v2
    v_lshlrev_b32 v4, 4, v4
    v_lshl_add_u32 v108, v3, 8, v4
    v_add_u32 v4, 4, v3
    v_xor_b32 v4, v4, v2
    v_lshlrev_b32 v4, 4, v4
    v_lshl_add_u32 v109, v3, 8, v4
    s_mov_b32 s14, 65536
    s_mov_b32 s15, 0x20000
    s_waitcnt lgkmcnt(0)
    s_add_u32 s12, s34, s100
    s_addc_u32 s13, s35, 0
    s_add_u32 m0, s85, 65536
    s_nop 0
    buffer_load_dwordx4 v108, s[12:15], s82 offen nt lds
    s_add_u32 s82, s82, 4096
    s_and_b32 s82, s82, 65535
    s_add_u32 m0, s85, 66560
    s_nop 0
    buffer_load_dwordx4 v109, s[12:15], s82 offen nt lds
    s_add_u32 s82, s82, 4096
    s_and_b32 s82, s82, 65535
    v_and_b32 v1, 63, v0
    s_mov_b32 s6, 0
    s_mov_b32 s7, 1
    s_mov_b32 s80, 400000
    s_mov_b32 s81, 0xff
    v_add_u32 v4, 8, v3
    v_xor_b32 v4, v4, v2
    v_lshlrev_b32 v4, 4, v4
    v_lshl_add_u32 v110, v3, 8, v4
    v_add_u32 v4, 12, v3
    v_xor_b32 v4, v4, v2
    v_lshlrev_b32 v4, 4, v4
    v_lshl_add_u32 v111, v3, 8, v4
    s_and_b32 s83, s3, 1
    s_lshl_b32 s83, s83, 2
    v_lshrrev_b32 v5, 5, v1
    v_lshl_add_u32 v5, v5, 1, s83
    v_and_b32 v6, 7, v1
    v_xor_b32 v6, v6, v5
    v_lshlrev_b32 v6, 4, v6
    v_lshrrev_b32 v7, 3, v1
    v_lshl_add_u32 v128, v7, 13, v6
    v_lshlrev_b32 v185, 4, v1
    v_lshlrev_b32 v186, 2, v1
    v_add_u32 v186, 1024, v186
    v_mov_b32 v8, 1073741824
    v_cmp_gt_u32 vcc, 32, v1
    s_nop 1
    v_cndmask_b32 v186, v8, v186, vcc
    s_mul_i32 s73, s5, 57
    s_lshr_b32 s73, s73, 9
    s_mul_i32 s83, s73, 9
    s_sub_u32 s74, s5, s83
    s_lshl_b32 s92, s74, 2
    s_add_u32 s92, s92, s3
    s_and_b32 s84, s5, 3
    s_mul_i32 s84, s84, 1179648
    s_xor_b32 s86, s5, 0
    s_lshr_b32 s86, s86, 2
    s_lshl_b32 s86, s86, 7
    s_add_u32 s84, s84, s86
    s_lshl_b32 s86, s4, 10
    s_add_u32 s84, s84, s86
    s_mul_i32 s87, s4, 98304
    s_add_u32 s87, s87, 131072
    s_lshl2_add_u32 s99, s5, s3
    s_mul_i32 s99, s99, 256
    s_add_u32 s99, s99, s87
    v_mov_b32 v136, -1
    v_mov_b32 v137, -1
    v_mov_b32 v138, -1
    v_mov_b32 v139, -1
    s_cmp_lt_u32 s5, 32
    s_cselect_b32 s86, 16, 0
    v_cmp_gt_u32 vcc, s86, v1
    s_nop 1
    v_cndmask_b32 v133, v8, v185, vcc
    s_mov_b32 s83, s100
    s_mov_b32 s8, s54
    s_mov_b32 s9, s55
    s_mov_b32 s10, 8388608
    s_mov_b32 s11, 0x20000
    buffer_load_dword v131, off, s[8:11], 0 sc1
    buffer_store_dwordx4 v[136:139], v133, s[8:11], s99 offen
    s_add_u32 m0, s85, 67584
    s_nop 0
    buffer_load_dwordx4 v110, s[12:15], s82 offen nt lds
    s_add_u32 s82, s82, 4096
    s_and_b32 s82, s82, 65535
    s_add_u32 m0, s85, 68608
    s_nop 0
    buffer_load_dwordx4 v111, s[12:15], s82 offen nt lds
    s_add_u32 s82, s82, 4096
    s_and_b32 s82, s82, 65535
    s_add_u32 s20, s38, s84
    s_addc_u32 s21, s39, 0
    s_mov_b32 s22, 1171584
    s_mov_b32 s23, 0x20000
    s_add_u32 s16, s36, s83
    s_addc_u32 s17, s37, 0
    s_mov_b32 s18, 65536
    s_mov_b32 s19, 0x20000
    s_lshl_b32 s83, s3, 16
    s_lshl_b32 s84, s3, 10
    s_add_u32 m0, s84, 139264
    s_nop 0
    buffer_load_dwordx4 v128, s[20:23], s83 offen nt lds
    s_add_u32 s83, s83, 262144
    s_add_u32 m0, m0, 4096
    s_nop 0
    buffer_load_dwordx4 v128, s[20:23], s83 offen nt lds
    s_add_u32 s83, s83, 262144
    s_add_u32 m0, m0, 4096
    s_nop 0
    buffer_load_dwordx4 v128, s[20:23], s83 offen nt lds
    s_add_u32 s83, s83, 262144
    s_add_u32 m0, m0, 4096
    s_nop 0
    buffer_load_dwordx4 v128, s[20:23], s83 offen nt lds
    s_cmp_eq_u32 s73, 1
    s_cselect_b32 s24, s44, s48
    s_cselect_b32 s25, s45, s49
    s_mov_b32 s83, 663552
    s_mov_b32 s84, 1152
    s_mov_b32 s26, 662528
    s_cselect_b32 s83, 1152, s83
    s_cselect_b32 s84, 9216, s84
    s_cselect_b32 s26, 5299328, s26
    s_mul_i32 s83, s83, s4
    s_lshl_b32 s86, s74, 7
    s_add_u32 s83, s83, s86
    s_add_u32 s24, s24, s83
    s_addc_u32 s25, s25, 0
    s_mov_b32 s27, 0x20000
    v_mul_lo_u32 v162, v7, s84
    v_add_u32 v162, v162, v6
    v_mul_u32_u24 v202, 1152, v7
    v_add_u32 v202, v202, v6
    s_mov_b32 s64, 0x33333333
    s_mov_b32 s65, 0x33333333
    v_lshrrev_b32 v4, 5, v1
    v_lshlrev_b32 v4, 4, v4
    v_and_b32 v5, 1, v3
    v_lshl_add_u32 v4, v5, 2, v4
    v_bfe_u32 v6, v1, 2, 1
    v_add_u32 v4, v4, v6
    v_bfe_u32 v7, v1, 3, 1
    v_lshl_add_u32 v4, v7, 3, v4
    v_lshl_add_u32 v5, v7, 1, v5
    v_and_b32 v7, 3, v1
    v_lshlrev_b32 v7, 3, v7
    v_xor_b32 v9, s3, v5
    v_lshl_add_u32 v9, v9, 5, v7
    v_lshl_add_u32 v9, v4, 7, v9
    v_add_u32 v163, 65536, v9
    v_add_u32 v164, 131072, v9
    v_add_u32 v129, 139264, v9
    v_lshl_add_u32 v5, v5, 1, v6
    s_lshl_b32 s83, s3, 1
    v_xor_b32 v5, s83, v5
    v_lshl_add_u32 v4, v4, 8, v7
    v_lshl_add_u32 v154, v5, 5, v4
    v_xor_b32 v5, 1, v5
    v_lshl_add_u32 v155, v5, 5, v4
    s_mul_i32 s83, s3, 1280
    s_add_u32 s83, s83, 157696
    v_add_u32 v165, s83, v185
    v_add_u32 v195, 131072, v185
    v_lshlrev_b32 v194, 2, v1
    v_add_u32 v194, 131072, v194
    s_add_u32 s84, s83, 1024
    v_lshl_add_u32 v193, v1, 2, s84
    v_and_b32 v4, 1, v1
    v_lshlrev_b32 v4, 4, v4
    v_lshl_add_u32 v4, v3, 5, v4
    v_add_u32 v166, s83, v4
    s_and_b32 s84, s5, 3
    s_mul_i32 s84, s84, 288
    s_add_u32 s84, s84, 157696
    v_add_u32 v167, s84, v4
    v_add_u32 v173, 140800, v4
    v_bfe_u32 v5, v1, 1, 1
    v_lshl_add_u32 v4, v5, 7, v4
    v_add_u32 v169, 139264, v4
    v_and_b32 v4, 1, v1
    v_mov_b32 v5, 0xaaaa
    v_mul_u32_u24 v5, v4, v5
    v_add_u32 v174, 0x4444, v5
    v_lshlrev_b32 v180, 3, v1
    v_lshlrev_b32 v197, 2, v1
    v_cmp_gt_u32 vcc, 16, v1
    s_nop 1
    v_cndmask_b32 v179, v8, v197, vcc
    s_add_u32 s83, s87, 32768
    s_xor_b32 s84, s5, 0
    s_lshl_b32 s84, s84, 8
    s_add_u32 s88, s83, s84
    s_lshl_b32 s84, s3, 6
    s_add_u32 s88, s88, s84
    s_lshr_b32 s84, s5, 4
    s_xor_b32 s84, s84, 1
    s_lshl2_add_u32 s86, s84, s3
    s_lshl_b32 s86, s86, 10
    s_add_u32 s89, s83, s86
    v_mov_b32 v24, 0x3f803f80
    v_mov_b32 v25, 0x3f803f80
    v_mov_b32 v26, 0x3f803f80
    v_mov_b32 v27, 0x3f803f80
    v_mov_b32 v28, 0x3f803f80
    v_mov_b32 v29, 0x3f803f80
    v_mov_b32 v30, 0x3f803f80
    v_mov_b32 v31, 0x3f803f80
    v_mov_b32 v32, 0x3f803f80
    v_mov_b32 v33, 0x3f803f80
    v_mov_b32 v34, 0x3f803f80
    v_mov_b32 v35, 0x3f803f80
    v_mov_b32 v116, 0
    v_mov_b32 v117, 0
    v_mov_b32 v118, 0
    v_mov_b32 v119, 0
    s_add_u32 m0, s85, 69632
    s_nop 0
    buffer_load_dwordx4 v108, s[12:15], s82 offen nt lds
    s_add_u32 s82, s82, 4096
    s_and_b32 s82, s82, 65535
    s_add_u32 m0, s85, 70656
    s_nop 0
    buffer_load_dwordx4 v109, s[12:15], s82 offen nt lds
    s_add_u32 s82, s82, 4096
    s_and_b32 s82, s82, 65535
    s_waitcnt vmcnt(8)
    v_readfirstlane_b32 s94, v131
    s_getreg_b32 s83, hwreg(HW_REG_XCC_ID, 0, 4)
    s_add_u32 s94, s94, 1
    s_mul_i32 s75, s94, 0x01010101
    s_andn2_b32 s79, s75, 15
    s_or_b32 s79, s79, s83
    v_and_b32 v4, 3, v1
    v_lshlrev_b32 v4, 3, v4
    v_bfe_u32 v178, s75, v4, 8
    v_mov_b32 v196, 0
    s_lshl_b32 s83, s4, 7
    s_lshl_b32 s84, s5, 2
    s_add_u32 s83, s83, s84
    s_add_u32 s83, s83, 4096
    v_mov_b32 v10, s79
    v_mov_b32 v11, 1073741824
    v_lshlrev_b32 v12, 2, v0
    v_cmp_gt_u32 vcc, 1, v0
    s_nop 1
    v_cndmask_b32 v11, v11, v12, vcc
    s_barrier
    buffer_store_dword v10, v11, s[8:11], s83 offen sc1
    s_and_b32 s84, s3, 1
    s_add_u32 s84, s84, 16
    s_lshl_b32 s83, s84, 16
    s_lshl_b32 s84, s84, 10
    s_add_u32 m0, s84, 139264
    s_nop 0
    buffer_load_dwordx4 v128, s[20:23], s83 offen nt lds
    s_mov_b32 s28, s32
    s_mov_b32 s29, s33
    s_mov_b32 s30, 1152
    s_mov_b32 s31, 0x20000
    buffer_load_dwordx4 v[16:19], v185, s[28:31], 0 offen
    buffer_load_dword v20, v186, s[28:31], 0 offen
    s_lshl_b32 s100, s92, 5
    v_lshl_add_u32 v4, v2, 1, s100
    buffer_load_ushort v132, v4, s[28:31], 0 offen
    s_mov_b32 s28, s46
    s_mov_b32 s29, s47
    s_mov_b32 s30, 9216
    v_lshl_add_u32 v4, v2, 1, s100
    s_mul_i32 s101, s4, 1152
    buffer_load_ushort v191, v4, s[28:31], s101 offen
    v_cmp_gt_u32 vcc, 16, v1
    s_nop 1
    v_cndmask_b32 v188, v8, v4, vcc
    s_add_u32 m0, s85, 71680
    s_nop 0
    buffer_load_dwordx4 v110, s[12:15], s82 offen nt lds
    s_add_u32 s82, s82, 4096
    s_and_b32 s82, s82, 65535
    s_add_u32 m0, s85, 72704
    s_nop 0
    buffer_load_dwordx4 v111, s[12:15], s82 offen nt lds
    s_add_u32 s82, s82, 4096
    s_and_b32 s82, s82, 65535
    s_add_u32 m0, s85, 73728
    s_nop 0
    buffer_load_dwordx4 v108, s[12:15], s82 offen nt lds
    s_add_u32 s82, s82, 4096
    s_and_b32 s82, s82, 65535
    s_add_u32 m0, s85, 74752
    s_nop 0
    buffer_load_dwordx4 v109, s[12:15], s82 offen nt lds
    s_add_u32 s82, s82, 4096
    s_and_b32 s82, s82, 65535
    s_mov_b32 s36, s54
    s_mov_b32 s37, s55
    s_mov_b32 s38, 8388608
    s_mov_b32 s39, 0x20000
    s_mov_b32 s32, s54
    s_mov_b32 s33, s55
    s_mov_b32 s34, 0
    s_mov_b32 s35, 0x20000
    s_mov_b32 s101, 0xff
    v_and_b32 v4, 1, v3
    v_lshlrev_b32 v4, 1, v4
    v_or_b32 v4, 0, v4
    v_xor_b32 v4, v4, v2
    v_lshlrev_b32 v4, 4, v4
    v_lshl_add_u32 v124, v3, 8, v4
    v_and_b32 v4, 1, v3
    v_lshlrev_b32 v4, 1, v4
    v_or_b32 v4, 4, v4
    v_xor_b32 v4, v4, v2
    v_lshlrev_b32 v4, 4, v4
    v_lshl_add_u32 v125, v3, 8, v4
    v_and_b32 v4, 1, v3
    v_lshlrev_b32 v4, 1, v4
    v_or_b32 v4, 8, v4
    v_xor_b32 v4, v4, v2
    v_lshlrev_b32 v4, 4, v4
    v_lshl_add_u32 v126, v3, 8, v4
    v_and_b32 v4, 1, v3
    v_lshlrev_b32 v4, 1, v4
    v_or_b32 v4, 12, v4
    v_xor_b32 v4, v4, v2
    v_lshlrev_b32 v4, 4, v4
    v_lshl_add_u32 v127, v3, 8, v4
    s_add_u32 s83, s85, 65536
    v_add_u32 v4, 0, v3
    v_xor_b32 v4, v4, v2
    v_lshlrev_b32 v4, 4, v4
    v_lshl_add_u32 v4, v2, 8, v4
    v_add_u32 v112, s83, v4
    v_add_u32 v4, 4, v3
    v_xor_b32 v4, v4, v2
    v_lshlrev_b32 v4, 4, v4
    v_lshl_add_u32 v4, v2, 8, v4
    v_add_u32 v113, s83, v4
    v_add_u32 v4, 8, v3
    v_xor_b32 v4, v4, v2
    v_lshlrev_b32 v4, 4, v4
    v_lshl_add_u32 v4, v2, 8, v4
    v_add_u32 v114, s83, v4
    v_add_u32 v4, 12, v3
    v_xor_b32 v4, v4, v2
    v_lshlrev_b32 v4, 4, v4
    v_lshl_add_u32 v4, v2, 8, v4
    v_add_u32 v115, s83, v4
    s_mov_b32 s56, 983055
    s_mov_b32 s57, 983055
    s_mov_b32 s58, 15728880
    s_mov_b32 s59, 15728880
    s_mov_b32 s60, 251662080
    s_mov_b32 s61, 251662080
    s_mov_b32 s62, 4026593280
    s_mov_b32 s63, 4026593280
    v_bfe_u32 v5, v1, 1, 1
    v_lshlrev_b32 v4, 5, v3
    v_lshl_add_u32 v4, v5, 4, v4
    v_bfe_u32 v5, v1, 2, 2
    v_lshl_add_u32 v4, v5, 2, v4
    v_and_b32 v5, 1, v1
    v_lshl_add_u32 v4, v5, 1, v4
    s_and_b32 s83, s3, 1
    s_lshl_b32 s83, s83, 8
    s_lshr_b32 s84, s3, 1
    s_lshl_b32 s84, s84, 7
    s_add_u32 s83, s83, s84
    s_add_u32 s83, s83, 139264
    v_add_u32 v168, s83, v4
    s_lshl_b32 s83, s3, 8
    s_add_u32 s84, s83, 139776
    v_lshl_add_u32 v170, v1, 1, s84
    v_lshlrev_b32 v4, 3, v3
    v_add_u32 v171, 162816, v4
    s_and_b32 s84, s83, 1023
    s_add_u32 s84, s84, 140800
    v_and_b32 v4, 8, v4
    v_lshl_add_u32 v4, v2, 4, v4
    v_add_u32 v172, s84, v4
    v_and_b32 v4, 3, v1
    v_xor_b32 v5, 1, v4
    v_lshl_add_u32 v4, v5, 2, v4
    v_mul_u32_u24 v175, 0x1111, v4
    v_bfe_u32 v4, v1, 2, 1
    v_mul_u32_u24 v177, 0xffff, v4
    v_xor_b32 v176, 0xffff, v177
    v_mov_b32 v200, 0
    s_lshr_b32 s84, s5, 4
    s_xor_b32 s84, s84, 1
    v_mov_b32 v8, 1073741824
    s_lshl_b32 s84, s84, 1
    s_and_b32 s83, s5, 15
    v_lshrrev_b32 v4, 5, v1
    v_add_u32 v4, s84, v4
    v_and_b32 v5, 31, v1
    v_lshlrev_b32 v130, 2, v5
    v_lshlrev_b32 v5, 1, v5
    v_lshl_add_u32 v5, v4, 12, v5
    s_lshl_b32 s86, s83, 2
    s_add_u32 s86, s86, s3
    s_lshl_b32 s100, s86, 6
    v_add_u32 v181, s100, v5
    v_lshrrev_b32 v4, 5, v1
    v_add_u32 v4, s84, v4
    v_lshlrev_b32 v4, 9, v4
    s_lshl_b32 s100, s86, 3
    s_add_u32 s100, s100, 16384
    v_add_u32 v4, s100, v4
    v_and_b32 v5, 31, v1
    v_cmp_eq_u32 vcc, 31, v5
    s_nop 1
    v_cndmask_b32 v182, v8, v4, vcc
    s_and_b32 s83, s3, 1
    s_and_b32 s86, s73, 2
    s_add_u32 s86, s86, s83
    s_cmp_eq_u32 s73, s73
    s_cselect_b32 s86, s3, s86
    s_lshl_b32 s83, s86, 12
    v_add_u32 v183, s83, v185
    v_lshrrev_b32 v4, 3, v2
    v_lshlrev_b32 v4, 3, v4
    v_lshl_add_u32 v4, v3, 1, v4
    v_bfe_u32 v5, v1, 2, 1
    v_add_u32 v4, v4, v5
    v_and_b32 v5, 3, v1
    v_lshlrev_b32 v5, 3, v5
    v_lshl_add_u32 v4, v4, 5, v5
    s_lshl_b32 s83, s86, 9
    s_add_u32 s83, s83, 16384
    v_add_u32 v184, s83, v4
    s_waitcnt vmcnt(6)
    s_add_u32 m0, s85, 75776
    s_nop 0
    buffer_load_dwordx4 v110, s[12:15], s82 offen nt lds
    s_add_u32 s82, s82, 4096
    s_and_b32 s82, s82, 65535
    s_add_u32 m0, s85, 76800
    s_nop 0
    buffer_load_dwordx4 v111, s[12:15], s82 offen nt lds
    s_add_u32 s82, s82, 4096
    s_and_b32 s82, s82, 65535
    s_add_u32 m0, s85, 77824
    s_nop 0
    buffer_load_dwordx4 v108, s[12:15], s82 offen nt lds
    s_add_u32 s82, s82, 4096
    s_and_b32 s82, s82, 65535
    s_add_u32 m0, s85, 78848
    s_nop 0
    buffer_load_dwordx4 v109, s[12:15], s82 offen nt lds
    s_add_u32 s82, s82, 4096
    s_and_b32 s82, s82, 65535
    s_waitcnt lgkmcnt(0)
    s_barrier
    ds_read_b64_tr_b16 a[128:129], v129 offset:0
    ds_read_b64_tr_b16 a[130:131], v129 offset:256
    ds_read_b64_tr_b16 a[132:133], v129 offset:4096
    ds_read_b64_tr_b16 a[134:135], v129 offset:4352
    ds_read_b64_tr_b16 a[136:137], v129 offset:8192
    ds_read_b64_tr_b16 a[138:139], v129 offset:8448
    ds_read_b64_tr_b16 a[140:141], v129 offset:12288
    ds_read_b64_tr_b16 a[142:143], v129 offset:12544
    ds_read_b64_tr_b16 a[144:145], v129 offset:16384
    ds_read_b64_tr_b16 a[146:147], v129 offset:16640
    v_accvgpr_write_b32 a148, 0
    v_accvgpr_write_b32 a149, 0
    v_accvgpr_write_b32 a150, 0
    v_accvgpr_write_b32 a151, 0
    s_waitcnt lgkmcnt(0)
    s_mov_b32 exec_lo, 0
    v_accvgpr_write_b32 a144, 0
    v_accvgpr_write_b32 a145, 0
    v_accvgpr_write_b32 a146, 0
    v_accvgpr_write_b32 a147, 0
    s_mov_b32 exec_lo, -1
    ds_write_b128 v165, v[16:19]
    ds_write_b32 v193, v20
    s_waitcnt lgkmcnt(0)
    s_barrier
    s_branch L_q
L_top:
    v_mov_b32 v116, 0
    v_mov_b32 v117, 0
    v_mov_b32 v118, 0
    v_mov_b32 v119, 0
    s_cmp_lg_u32 s3, 0
    s_cbranch_scc1 L_xbar
    s_cmp_eq_u32 s73, 0
    s_cbranch_scc1 L_top2
    s_add_u32 s83, s87, 4294938624
L_pw1:
    buffer_load_dword v4, off, s[8:11], s83 sc1
    s_sub_u32 s80, s80, 1
    s_cbranch_scc1 L_pd2
    s_waitcnt vmcnt(0)
    v_cmp_eq_u32 vcc, -1, v4
    s_cbranch_vccz L_pd2b
    s_sleep 2
    s_branch L_pw1
L_pd2:
    s_mov_b32 s80, 0
L_pd2b:
L_top2:
    s_add_u32 s85, s87, -26624
L_xs3:
    buffer_load_dwordx4 v[16:19], v185, s[8:11], s85 offen sc1
    buffer_load_dword v20, v186, s[8:11], s85 offen sc1
    s_sleep 2
L_xl4:
    buffer_load_dwordx4 v[136:139], v185, s[8:11], s85 offen sc1
    buffer_load_dword v140, v186, s[8:11], s85 offen sc1
    s_sub_u32 s80, s80, 1
    s_cbranch_scc1 L_xt7
    s_waitcnt vmcnt(2)
    v_max3_u32 v4, v16, v17, v18
    v_max3_u32 v4, v4, v19, v20
    v_cmp_eq_u32 vcc, -1, v4
    s_cbranch_vccz L_xa5
    buffer_load_dwordx4 v[16:19], v185, s[8:11], s85 offen sc1
    buffer_load_dword v20, v186, s[8:11], s85 offen sc1
    s_waitcnt vmcnt(2)
    v_max3_u32 v4, v136, v137, v138
    v_max3_u32 v4, v4, v139, v140
    v_cmp_eq_u32 vcc, -1, v4
    s_cbranch_vccnz L_xl4
    ds_write_b128 v165, v[136:139]
    ds_write_b32 v193, v140
    s_branch L_xd6
L_xa5:
    ds_write_b128 v165, v[16:19]
    ds_write_b32 v193, v20
L_xd6:
    s_waitcnt lgkmcnt(0)
L_xbar:
    s_barrier
L_q:
    s_mov_b64 exec, s[64:65]
    ds_read_b128 v[24:27], v167 offset:0
    ds_read_b128 v[28:31], v167 offset:128
    ds_read_b128 v[32:35], v167 offset:256
    s_mov_b64 exec, -1
    ds_read_b128 v[16:19], v195 offset:26624
    ds_read_b32 v20, v194 offset:27648
    s_waitcnt lgkmcnt(4)
    v_smfmac_f32_16x16x64_bf16 v[116:119], v[24:27], a[128:135], v174
    s_waitcnt lgkmcnt(3)
    v_smfmac_f32_16x16x64_bf16 v[116:119], v[28:31], a[136:143], v174
    s_waitcnt lgkmcnt(2)
    v_smfmac_f32_16x16x64_bf16 v[116:119], v[32:35], a[144:151], v174
    s_nop 7
    v_add_f32 v4, v116, v117
    v_bfi_b32 v148, s101, v178, v4
    buffer_store_dword v148, v179, s[36:39], s88 offen sc0
    buffer_store_dword v148, v179, s[32:35], s88 offen sc1
    s_cmp_eq_u32 s6, 0
    s_cbranch_scc1 L_c113
L_h1s8:
    s_waitcnt lgkmcnt(0)
    v_mov_b32 v6, 0
    v_mov_b32 v7, 0
    v_dot2c_f32_bf16 v6, 0x3f803f80, v16
    v_dot2c_f32_bf16 v7, v16, v16
    v_dot2c_f32_bf16 v6, 0x3f803f80, v17
    v_dot2c_f32_bf16 v7, v17, v17
    v_dot2c_f32_bf16 v6, 0x3f803f80, v18
    v_dot2c_f32_bf16 v7, v18, v18
    v_dot2c_f32_bf16 v6, 0x3f803f80, v19
    v_dot2c_f32_bf16 v7, v19, v19
    v_dot2c_f32_bf16 v6, 0x3f803f80, v20
    v_dot2c_f32_bf16 v7, v20, v20
    s_nop 1
    v_add_f32_dpp v6, v6, v6 row_ror:1 row_mask:0xf bank_mask:0xf
    v_add_f32_dpp v7, v7, v7 row_ror:1 row_mask:0xf bank_mask:0xf
    s_nop 0
    v_add_f32_dpp v6, v6, v6 row_ror:2 row_mask:0xf bank_mask:0xf
    v_add_f32_dpp v7, v7, v7 row_ror:2 row_mask:0xf bank_mask:0xf
    s_nop 0
    v_add_f32_dpp v6, v6, v6 row_ror:4 row_mask:0xf bank_mask:0xf
    v_add_f32_dpp v7, v7, v7 row_ror:4 row_mask:0xf bank_mask:0xf
    s_nop 0
    v_add_f32_dpp v6, v6, v6 row_ror:8 row_mask:0xf bank_mask:0xf
    v_add_f32_dpp v7, v7, v7 row_ror:8 row_mask:0xf bank_mask:0xf
    s_nop 0
    v_add_f32_dpp v6, v6, v6 row_bcast:15 row_mask:0xa bank_mask:0xf
    v_add_f32_dpp v7, v7, v7 row_bcast:15 row_mask:0xa bank_mask:0xf
    s_nop 0
    v_add_f32_dpp v6, v6, v6 row_bcast:31 row_mask:0xc bank_mask:0xf
    v_add_f32_dpp v7, v7, v7 row_bcast:31 row_mask:0xc bank_mask:0xf
    buffer_load_dword v92, v197, s[8:11], s89 offen offset:0 sc1
    buffer_load_dword v93, v197, s[8:11], s89 offen offset:256 sc1
    buffer_load_dword v94, v197, s[8:11], s89 offen offset:512 sc1
    buffer_load_dword v95, v197, s[8:11], s89 offen offset:768 sc1
    v_readlane_b32 s83, v6, 63
    v_readlane_b32 s84, v7, 63
    v_mov_b32 v6, 0x3ae38e39
    v_mul_f32 v189, s83, v6
    v_mul_f32 v7, s84, v6
    v_fma_f32 v7, -v189, v189, v7
    v_max_f32 v7, 0, v7
    v_add_f32 v7, 0x3727c5ac, v7
    v_rsq_f32 v190, v7
    v_mov_b32 v116, 0
    v_mov_b32 v117, 0
    v_mov_b32 v118, 0
    v_mov_b32 v119, 0
    v_mov_b32 v120, 0
    v_mov_b32 v121, 0
    v_mov_b32 v122, 0
    v_mov_b32 v123, 0
    v_mul_f32 v199, v189, v190
    v_mul_f32 v199, -v199, v196
L_h1l9:
    buffer_load_dword v100, v197, s[8:11], s89 offen offset:0 sc1
    buffer_load_dword v101, v197, s[8:11], s89 offen offset:256 sc1
    buffer_load_dword v102, v197, s[8:11], s89 offen offset:512 sc1
    buffer_load_dword v103, v197, s[8:11], s89 offen offset:768 sc1
    s_sub_u32 s80, s80, 1
    s_cbranch_scc1 L_h1t12
    s_waitcnt vmcnt(4)
    v_max3_u32 v4, v92, v93, v94
    v_max3_u32 v4, v4, v95, v95
    v_cmp_eq_u32 vcc, -1, v4
    s_cbranch_vccz L_h1a10
    buffer_load_dword v92, v197, s[8:11], s89 offen offset:0 sc1
    buffer_load_dword v93, v197, s[8:11], s89 offen offset:256 sc1
    buffer_load_dword v94, v197, s[8:11], s89 offen offset:512 sc1
    buffer_load_dword v95, v197, s[8:11], s89 offen offset:768 sc1
    s_waitcnt vmcnt(4)
    v_max3_u32 v4, v100, v101, v102
    v_max3_u32 v4, v4, v103, v103
    v_cmp_eq_u32 vcc, -1, v4
    s_cbranch_vccnz L_h1l9
    v_pk_add_f32 v[4:5], v[100:101], v[102:103]
    s_branch L_h1d11
L_h1a10:
    v_pk_add_f32 v[4:5], v[92:93], v[94:95]
L_h1d11:
    v_add_f32 v4, v4, v5
    v_fma_f32 v4, v190, v4, v199
    v_cvt_pk_bf16_f32 v4, v4, v4
    ds_write_b16 v168, v4
    s_waitcnt lgkmcnt(0)
    s_barrier
    s_mov_b64 exec, s[56:57]
    ds_read_b128 v[60:63], v169 offset:0
    ds_read_b128 v[76:79], v169 offset:256
    s_mov_b64 exec, s[58:59]
    ds_read_b128 v[64:67], v169 offset:0
    ds_read_b128 v[80:83], v169 offset:256
    s_mov_b64 exec, s[60:61]
    ds_read_b128 v[68:71], v169 offset:0
    ds_read_b128 v[84:87], v169 offset:256
    s_mov_b64 exec, s[62:63]
    ds_read_b128 v[72:75], v169 offset:0
    ds_read_b128 v[88:91], v169 offset:256
    s_mov_b64 exec, -1
    s_waitcnt lgkmcnt(7)
    v_smfmac_f32_16x16x64_bf16 v[116:119], v[60:63], a[0:7], v174
    s_waitcnt lgkmcnt(6)
    v_smfmac_f32_16x16x64_bf16 v[116:119], v[76:79], a[8:15], v174
    s_waitcnt lgkmcnt(5)
    v_smfmac_f32_16x16x64_bf16 v[116:119], v[64:67], a[16:23], v174
    s_waitcnt lgkmcnt(4)
    v_smfmac_f32_16x16x64_bf16 v[116:119], v[80:83], a[24:31], v174
    s_waitcnt lgkmcnt(3)
    v_smfmac_f32_16x16x64_bf16 v[116:119], v[68:71], a[32:39], v174
    s_waitcnt lgkmcnt(2)
    v_smfmac_f32_16x16x64_bf16 v[116:119], v[84:87], a[40:47], v174
    s_waitcnt lgkmcnt(1)
    v_smfmac_f32_16x16x64_bf16 v[116:119], v[72:75], a[48:55], v174
    s_waitcnt lgkmcnt(0)
    v_smfmac_f32_16x16x64_bf16 v[116:119], v[88:91], a[56:63], v174
    s_nop 7
    v_add_f32 v160, v116, v117
    v_add_f32 v161, v118, v119
    v_mul_f32 v160, 0x3e0293ee, v160
    v_mul_f32 v161, 0x3e0293ee, v161
    s_nop 0
    v_max_f32_dpp v4, v160, v160 row_ror:1 row_mask:0xf bank_mask:0xf
    v_max_f32_dpp v5, v161, v161 row_ror:1 row_mask:0xf bank_mask:0xf
    v_mov_b32 v116, 0
    v_max_f32_dpp v4, v4, v4 row_ror:2 row_mask:0xf bank_mask:0xf
    v_max_f32_dpp v5, v5, v5 row_ror:2 row_mask:0xf bank_mask:0xf
    v_mov_b32 v117, 0
    v_max_f32_dpp v4, v4, v4 row_ror:4 row_mask:0xf bank_mask:0xf
    v_max_f32_dpp v5, v5, v5 row_ror:4 row_mask:0xf bank_mask:0xf
    v_mov_b32 v118, 0
    v_max_f32_dpp v4, v4, v4 row_ror:8 row_mask:0xf bank_mask:0xf
    v_max_f32_dpp v5, v5, v5 row_ror:8 row_mask:0xf bank_mask:0xf
    v_mov_b32 v119, 0
    v_max_f32_dpp v4, v4, v4 row_bcast:15 row_mask:0xa bank_mask:0xf
    v_max_f32_dpp v5, v5, v5 row_bcast:15 row_mask:0xa bank_mask:0xf
    s_nop 0
    v_max_f32_dpp v4, v4, v4 row_bcast:31 row_mask:0xc bank_mask:0xf
    v_max_f32_dpp v5, v5, v5 row_bcast:31 row_mask:0xc bank_mask:0xf
    v_readlane_b32 s95, v4, 63
    v_readlane_b32 s96, v5, 63
    s_nop 0
    v_subrev_f32 v160, s95, v160
    v_subrev_f32 v161, s96, v161
    v_exp_f32 v160, v160
    v_exp_f32 v161, v161
    v_mov_b32 v6, s95
    v_mov_b32 v7, s96
    v_cvt_pk_bf16_f32 v4, v160, v161
    s_lshl_b32 s83, s3, 3
    s_add_u32 s83, s83, 162816
    ds_write_b16 v170, v4
    ds_write_b16_d16_hi v170, v4 offset:128
    v_mov_b32 v8, s83
    s_mov_b64 exec, 1
    ds_write_b64 v8, v[6:7]
    s_mov_b64 exec, -1
    v_permlane32_swap_b32 v160, v161
    v_mov_b32 v10, s95
    v_add_f32 v11, v160, v161
    v_writelane_b32 v10, s96, 63
    s_nop 0
    v_add_f32_dpp v11, v11, v11 row_ror:1 row_mask:0xf bank_mask:0xf
    s_nop 1
    v_add_f32_dpp v11, v11, v11 row_ror:2 row_mask:0xf bank_mask:0xf
    s_nop 1
    v_add_f32_dpp v11, v11, v11 row_ror:4 row_mask:0xf bank_mask:0xf
    s_nop 1
    v_add_f32_dpp v11, v11, v11 row_ror:8 row_mask:0xf bank_mask:0xf
    s_nop 1
    v_add_f32_dpp v11, v11, v11 row_bcast:15 row_mask:0xa bank_mask:0xf
    buffer_store_dwordx2 v[10:11], v182, s[36:39], s87 offen sc0
    buffer_store_dwordx2 v[10:11], v182, s[32:35], s87 offen sc1
    s_cmp_lg_u32 s6, 0
    s_cbranch_scc0 L_no29
    s_waitcnt lgkmcnt(0)
    s_barrier
    s_mov_b64 exec, s[56:57]
    ds_read_b128 v[60:63], v169 offset:512
    s_mov_b64 exec, s[58:59]
    ds_read_b128 v[64:67], v169 offset:768
    s_mov_b64 exec, s[60:61]
    ds_read_b128 v[68:71], v169 offset:1024
    s_mov_b64 exec, s[62:63]
    ds_read_b128 v[72:75], v169 offset:1280
    s_mov_b64 exec, -1
    v_mov_b32 v8, 162816
    ds_read_b128 v[124:127], v8
    ds_read_b128 v[128:131], v8 offset:16
    ds_read_b64 v[132:133], v171
    s_waitcnt lgkmcnt(6)
    v_smfmac_f32_16x16x64_bf16 v[116:119], v[60:63], a[64:71], v174
    v_smfmac_f32_16x16x64_bf16 v[120:123], v[60:63], a[72:79], v174
    s_waitcnt lgkmcnt(5)
    v_smfmac_f32_16x16x64_bf16 v[116:119], v[64:67], a[80:87], v174
    v_smfmac_f32_16x16x64_bf16 v[120:123], v[64:67], a[88:95], v174
    s_waitcnt lgkmcnt(4)
    v_smfmac_f32_16x16x64_bf16 v[116:119], v[68:71], a[96:103], v174
    v_smfmac_f32_16x16x64_bf16 v[120:123], v[68:71], a[104:111], v174
    s_waitcnt lgkmcnt(3)
    v_smfmac_f32_16x16x64_bf16 v[116:119], v[72:75], a[112:119], v174
    v_smfmac_f32_16x16x64_bf16 v[120:123], v[72:75], a[120:127], v174
    buffer_load_dwordx2 v[150:151], v184, s[8:11], s87 offen sc1
L_pj30:
    s_waitcnt lgkmcnt(0)
    v_max3_f32 v8, v124, v126, v128
    v_max3_f32 v9, v125, v127, v129
    v_max_f32 v8, v8, v130
    v_max_f32 v9, v9, v131
    v_sub_f32 v8, v132, v8
    v_sub_f32 v9, v133, v9
    v_exp_f32 v8, v8
    v_exp_f32 v9, v9
    v_add_f32 v4, v116, v117
    v_add_f32 v5, v118, v119
    v_add_f32 v6, v120, v121
    v_add_f32 v7, v122, v123
    v_mul_f32 v4, v8, v4
    v_mul_f32 v5, v9, v5
    v_mul_f32 v6, v8, v6
    v_mul_f32 v7, v9, v7
    v_permlane32_swap_b32 v4, v5
    s_nop 0
    v_permlane32_swap_b32 v6, v7
    v_add_f32 v4, v4, v5
    v_add_f32 v6, v6, v7
    s_nop 1
    v_permlane16_swap_b32 v4, v6
    v_add_f32 v4, v4, v6
    v_cvt_pk_bf16_f32 v4, v4, v4
    buffer_store_short v4, v181, s[36:39], s87 offen sc0
    buffer_store_short v4, v181, s[32:35], s87 offen sc1
    v_mov_b32 v116, 0
    v_mov_b32 v117, 0
    v_mov_b32 v118, 0
    v_mov_b32 v119, 0
    v_mov_b32 v120, 0
    v_mov_b32 v121, 0
    v_mov_b32 v122, 0
    v_mov_b32 v123, 0
    s_cmp_lg_u32 s73, 0
    s_cbranch_scc1 L_other
    s_lshl_b32 s97, s4, 11
    s_and_b32 s97, s97, 8192
    s_xor_b32 s97, s97, s91
    s_xor_b32 s98, s97, 8192
    s_add_u32 s97, s97, s90
    s_add_u32 s98, s98, s90
    s_cmp_eq_u32 s6, 0
    s_cbranch_scc1 L_o1
L_o1b:
    s_waitcnt vmcnt(2)
    v_max_u32 v4, v150, v151
    v_cmp_eq_u32 vcc, -1, v4
    s_cbranch_vccz L_meb
L_mes31:
    buffer_load_dwordx2 v[124:125], v184, s[8:11], s87 offen sc1
    s_sleep 2
L_mel32:
    buffer_load_dwordx2 v[150:151], v184, s[8:11], s87 offen sc1
    s_sub_u32 s80, s80, 1
    s_cbranch_scc1 L_met35
    s_waitcnt vmcnt(1)
    v_max_u32 v4, v124, v125
    v_cmp_eq_u32 vcc, -1, v4
    s_cbranch_vccz L_mea33
    buffer_load_dwordx2 v[124:125], v184, s[8:11], s87 offen sc1
    s_waitcnt vmcnt(1)
    v_max_u32 v4, v150, v151
    v_cmp_eq_u32 vcc, -1, v4
    s_cbranch_vccnz L_mel32
L_meb:
    v_mov_b32 v10, v150
    v_mov_b32 v11, v151
    s_branch L_med34
L_mea33:
    v_mov_b32 v10, v124
    v_mov_b32 v11, v125
L_med34:
L_os:
    s_nop 0
    v_max_f32_dpp v8, v10, v10 quad_perm:[1,0,3,2] row_mask:0xf bank_mask:0xf
    s_nop 1
    v_max_f32_dpp v8, v8, v8 quad_perm:[2,3,0,1] row_mask:0xf bank_mask:0xf
    s_nop 1
    v_max_f32_dpp v9, v8, v8 row_ror:4 row_mask:0xf bank_mask:0xf
    s_nop 1
    v_max_f32_dpp v9, v9, v9 row_ror:8 row_mask:0xf bank_mask:0xf
    s_nop 1
    v_max_f32_dpp v9, v9, v9 row_bcast:15 row_mask:0xa bank_mask:0xf
    s_nop 1
    v_max_f32_dpp v9, v9, v9 row_bcast:31 row_mask:0xc bank_mask:0xf
    s_nop 0
    v_readlane_b32 s83, v9, 63
    s_nop 1
    v_subrev_f32 v10, s83, v10
    v_subrev_f32 v8, s83, v8
    v_exp_f32 v10, v10
    v_exp_f32 v8, v8
    v_mul_f32 v11, v10, v11
    buffer_load_dwordx4 v[92:95], v183, s[8:11], s87 offen offset:0 sc1
    buffer_load_dwordx4 v[96:99], v183, s[8:11], s87 offen offset:1024 sc1
    buffer_load_dwordx4 v[100:103], v183, s[8:11], s87 offen offset:2048 sc1
    buffer_load_dwordx4 v[104:107], v183, s[8:11], s87 offen offset:3072 sc1
    v_add_f32_dpp v11, v11, v11 row_ror:1 row_mask:0xf bank_mask:0xf
    s_nop 1
    v_add_f32_dpp v11, v11, v11 row_ror:2 row_mask:0xf bank_mask:0xf
    s_nop 1
    v_add_f32_dpp v11, v11, v11 row_ror:4 row_mask:0xf bank_mask:0xf
    s_nop 1
    v_add_f32_dpp v11, v11, v11 row_ror:8 row_mask:0xf bank_mask:0xf
    s_nop 1
    v_add_f32_dpp v11, v11, v11 row_bcast:15 row_mask:0xa bank_mask:0xf
    s_nop 1
    v_add_f32_dpp v11, v11, v11 row_bcast:31 row_mask:0xc bank_mask:0xf
    s_nop 0
    v_readlane_b32 s83, v11, 63
    s_nop 1
    v_rcp_f32 v11, s83
    s_nop 0
    v_mul_f32 v8, v8, v11
    v_cvt_pk_bf16_f32 v8, v8, v8
    s_nop 1
    v_and_b32_dpp v108, v8, v176 row_newbcast:0 row_mask:0xf bank_mask:0xf
    v_and_b32_dpp v109, v8, v177 row_newbcast:0 row_mask:0xf bank_mask:0xf
    v_and_b32_dpp v110, v8, v176 row_newbcast:4 row_mask:0xf bank_mask:0xf
    v_and_b32_dpp v111, v8, v177 row_newbcast:4 row_mask:0xf bank_mask:0xf
    v_and_b32_dpp v112, v8, v176 row_newbcast:8 row_mask:0xf bank_mask:0xf
    v_and_b32_dpp v113, v8, v177 row_newbcast:8 row_mask:0xf bank_mask:0xf
    v_and_b32_dpp v114, v8, v176 row_newbcast:12 row_mask:0xf bank_mask:0xf
    v_and_b32_dpp v115, v8, v177 row_newbcast:12 row_mask:0xf bank_mask:0xf
L_oloop:
    s_waitcnt vmcnt(0)
    v_max3_u32 v4, v92, v96, v100
    v_max3_u32 v4, v4, v104, v104
    v_cmp_eq_u32 vcc, -1, v4
    s_cbranch_vccnz L_oretry
L_oa:
    v_smfmac_f32_16x16x64_bf16 v[120:123], v[108:111], v[92:99], v175
    v_smfmac_f32_16x16x64_bf16 v[120:123], v[112:115], v[100:107], v175
    s_nop 7
    v_cvt_pk_bf16_f32 v4, v120, v121
    v_cvt_pk_bf16_f32 v5, v122, v123
    s_mov_b32 exec_hi, 0
    ds_write_b64 v172, v[4:5]
L_obar:
    s_mov_b64 exec, s[64:65]
    s_waitcnt lgkmcnt(0)
    s_barrier
    ds_read_b128 v[24:27], v173 offset:0
    ds_read_b128 v[28:31], v173 offset:128
    ds_read_b128 v[32:35], v173 offset:256
    ds_read_b128 v[36:39], v173 offset:384
    ds_read_b128 v[40:43], v173 offset:512
    ds_read_b128 v[44:47], v173 offset:640
    ds_read_b128 v[48:51], v173 offset:768
    ds_read_b128 v[52:55], v173 offset:896
    s_mov_b64 exec, -1
    s_waitcnt lgkmcnt(7)
    v_smfmac_f32_16x16x64_bf16 v[116:119], v[24:27], a[152:159], v174
    s_waitcnt lgkmcnt(6)
    v_smfmac_f32_16x16x64_bf16 v[116:119], v[28:31], a[160:167], v174
    s_waitcnt lgkmcnt(5)
    v_smfmac_f32_16x16x64_bf16 v[116:119], v[32:35], a[168:175], v174
    s_waitcnt lgkmcnt(4)
    v_smfmac_f32_16x16x64_bf16 v[116:119], v[36:39], a[176:183], v174
    s_waitcnt lgkmcnt(3)
    v_smfmac_f32_16x16x64_bf16 v[116:119], v[40:43], a[184:191], v174
    s_waitcnt lgkmcnt(2)
    v_smfmac_f32_16x16x64_bf16 v[116:119], v[44:47], a[192:199], v174
    s_waitcnt lgkmcnt(1)
    v_smfmac_f32_16x16x64_bf16 v[116:119], v[48:51], a[200:207], v174
    s_waitcnt lgkmcnt(0)
    v_smfmac_f32_16x16x64_bf16 v[116:119], v[52:55], a[208:215], v174
    s_nop 7
    v_add_f32 v4, v116, v117
    v_bfi_b32 v4, s81, v178, v4
    buffer_store_dword v4, v158, s[8:11], s97 offen sc1
    buffer_store_dword v4, v159, s[8:11], s98 offen sc1
    buffer_store_dword v4, v158, s[8:11], s98 offen sc1
    buffer_store_dword v4, v159, s[8:11], s97 offen sc1
    s_cmp_lg_u32 s6, 0
    s_cbranch_scc1 L_tw36
    s_add_u32 s83, s87, 23808
    buffer_load_dwordx2 v[10:11], v180, s[8:11], s83 offen sc1
    s_waitcnt vmcnt(0)
    v_min_u32_dpp v10, v10, v10 row_ror:1 row_mask:0xf bank_mask:0xf
    v_min_u32_dpp v11, v11, v11 row_ror:1 row_mask:0xf bank_mask:0xf
    s_nop 0
    v_min_u32_dpp v10, v10, v10 row_ror:2 row_mask:0xf bank_mask:0xf
    v_min_u32_dpp v11, v11, v11 row_ror:2 row_mask:0xf bank_mask:0xf
    s_nop 0
    v_min_u32_dpp v10, v10, v10 row_ror:4 row_mask:0xf bank_mask:0xf
    v_min_u32_dpp v11, v11, v11 row_ror:4 row_mask:0xf bank_mask:0xf
    s_nop 0
    v_min_u32_dpp v10, v10, v10 row_ror:8 row_mask:0xf bank_mask:0xf
    v_min_u32_dpp v11, v11, v11 row_ror:8 row_mask:0xf bank_mask:0xf
    s_nop 0
    v_min_u32_dpp v10, v10, v10 row_bcast:15 row_mask:0xa bank_mask:0xf
    v_min_u32_dpp v11, v11, v11 row_bcast:15 row_mask:0xa bank_mask:0xf
    s_nop 0
    v_min_u32_dpp v10, v10, v10 row_bcast:31 row_mask:0xc bank_mask:0xf
    v_min_u32_dpp v11, v11, v11 row_bcast:31 row_mask:0xc bank_mask:0xf
    v_readlane_b32 s83, v10, 63
    v_readlane_b32 s84, v11, 63
    s_cmp_lt_u32 s84, s83
    s_cselect_b32 s91, 8192, 0
L_tw36:
    s_add_u32 s86, s87, 18432
    s_add_u32 s85, s90, s91
L_rs37:
    buffer_load_dword v92, v187, s[8:11], s85 offen sc1
    buffer_load_dword v93, v187, s[8:11], s85 offen offset:256 sc1
    s_sleep 2
L_rl38:
    buffer_load_dword v100, v187, s[8:11], s85 offen sc1
    buffer_load_dword v101, v187, s[8:11], s85 offen offset:256 sc1
    s_sub_u32 s80, s80, 1
    s_cbranch_scc1 L_rt41
    s_waitcnt vmcnt(2)
    v_xor_b32 v4, v92, v178
    v_xor_b32 v6, v93, v178
    v_add_f32 v5, v4, v6
    v_or_b32 v4, v4, v6
    v_cmp_ne_u32_sdwa vcc, v4, v200 src0_sel:BYTE_0 src1_sel:DWORD
    s_cbranch_vccz L_ra39
    buffer_load_dword v92, v187, s[8:11], s85 offen sc1
    buffer_load_dword v93, v187, s[8:11], s85 offen offset:256 sc1
    s_waitcnt vmcnt(2)
    v_xor_b32 v4, v100, v178
    v_xor_b32 v6, v101, v178
    v_add_f32 v5, v4, v6
    v_or_b32 v4, v4, v6
    v_cmp_ne_u32_sdwa vcc, v4, v200 src0_sel:BYTE_0 src1_sel:DWORD
    s_cbranch_vccnz L_rl38
L_ra39:
    v_mfma_f32_16x16x4_f32 v[120:123], v198, v5, v[144:147]
    s_nop 9
    v_cvt_pk_bf16_f32 v4, v120, v120
    buffer_store_short v4, v188, s[36:39], s86 offen sc0
    buffer_store_short v4, v188, s[32:35], s86 offen sc1
    v_lshlrev_b32 v144, 16, v4
    s_cmp_lg_u32 s6, 0
    s_cbranch_scc1 L_tw42
    s_add_u32 s83, s87, 23808
    buffer_load_dwordx2 v[10:11], v180, s[8:11], s83 offen sc1
    s_waitcnt vmcnt(0)
    v_min_u32_dpp v10, v10, v10 row_ror:1 row_mask:0xf bank_mask:0xf
    v_min_u32_dpp v11, v11, v11 row_ror:1 row_mask:0xf bank_mask:0xf
    s_nop 0
    v_min_u32_dpp v10, v10, v10 row_ror:2 row_mask:0xf bank_mask:0xf
    v_min_u32_dpp v11, v11, v11 row_ror:2 row_mask:0xf bank_mask:0xf
    s_nop 0
    v_min_u32_dpp v10, v10, v10 row_ror:4 row_mask:0xf bank_mask:0xf
    v_min_u32_dpp v11, v11, v11 row_ror:4 row_mask:0xf bank_mask:0xf
    s_nop 0
    v_min_u32_dpp v10, v10, v10 row_ror:8 row_mask:0xf bank_mask:0xf
    v_min_u32_dpp v11, v11, v11 row_ror:8 row_mask:0xf bank_mask:0xf
    s_nop 0
    v_min_u32_dpp v10, v10, v10 row_bcast:15 row_mask:0xa bank_mask:0xf
    v_min_u32_dpp v11, v11, v11 row_bcast:15 row_mask:0xa bank_mask:0xf
    s_nop 0
    v_min_u32_dpp v10, v10, v10 row_bcast:31 row_mask:0xc bank_mask:0xf
    v_min_u32_dpp v11, v11, v11 row_bcast:31 row_mask:0xc bank_mask:0xf
    v_readlane_b32 s83, v10, 63
    v_readlane_b32 s84, v11, 63
    s_cmp_lt_u32 s84, s83
    s_cselect_b32 s91, 8192, 0
    v_lshlrev_b32 v12, 7, v1
    s_mov_b64 exec, 3
    buffer_load_dword v192, v12, s[8:11], s99 offen sc1
    s_mov_b64 exec, -1
    s_or_b32 s83, s92, s4
    s_cmp_lg_u32 s83, 0
    s_cbranch_scc1 L_fin2
    v_mov_b32 v5, s94
    s_mov_b64 exec, 1
    buffer_store_dword v5, off, s[8:11], 0 sc1
    s_mov_b64 exec, -1
L_fin2:
    v_bfe_u32 v4, v1, 2, 2
    v_add_u32 v4, 1, v4
    v_mul_u32_u24 v4, 294912, v4
    v_and_b32 v5, 3, v1
    v_readfirstlane_b32 s83, v187
    v_lshl_add_u32 v4, v5, 7, v4
    s_and_b32 s84, s92, 0
    s_lshl_b32 s84, s84, 9
    s_add_u32 s83, s83, s84
    s_add_u32 s83, s83, s90
    s_add_u32 s83, s83, s91
    s_mov_b64 exec, 0xfff
    buffer_load_dword v192, v4, s[8:11], s83 offen sc1
    s_mov_b64 exec, -1
L_tw42:
    s_mov_b32 s28, s36
    s_mov_b32 s29, s37
    s_mov_b32 s30, s38
    s_add_u32 s86, s87, 22528
    s_cmp_eq_u32 s6, 0
    s_cbranch_scc1 L_r243
    s_and_b32 s83, s74, 7
    s_cmp_lg_u32 s83, s4
    s_cbranch_scc1 L_exit
    s_mov_b32 s28, s50
    s_mov_b32 s29, s51
    s_mov_b32 s30, 1152
    s_mov_b32 s31, 0x20000
    s_mov_b32 s86, 0
L_r243:
    s_add_u32 s83, s87, 20480
L_pw44:
    buffer_load_dword v4, off, s[8:11], s83 sc1
    s_sub_u32 s80, s80, 1
    s_cbranch_scc1 L_pd45
    s_waitcnt vmcnt(0)
    v_cmp_eq_u32 vcc, -1, v4
    s_cbranch_vccz L_pd45b
    s_sleep 2
    s_branch L_pw44
L_pd45:
    s_mov_b32 s80, 0
L_pd45b:
    s_add_u32 s85, s90, s91
L_rs46:
    buffer_load_dword v92, v201, s[8:11], s85 offen sc1
    buffer_load_dword v93, v201, s[8:11], s85 offen offset:256 sc1
    s_sleep 2
L_rl47:
    buffer_load_dword v100, v201, s[8:11], s85 offen sc1
    buffer_load_dword v101, v201, s[8:11], s85 offen offset:256 sc1
    s_sub_u32 s80, s80, 1
    s_cbranch_scc1 L_rt50
    s_waitcnt vmcnt(2)
    v_xor_b32 v4, v92, v178
    v_xor_b32 v6, v93, v178
    v_add_f32 v5, v4, v6
    v_or_b32 v4, v4, v6
    v_cmp_ne_u32_sdwa vcc, v4, v200 src0_sel:BYTE_0 src1_sel:DWORD
    s_cbranch_vccz L_ra48
    buffer_load_dword v92, v201, s[8:11], s85 offen sc1
    buffer_load_dword v93, v201, s[8:11], s85 offen offset:256 sc1
    s_waitcnt vmcnt(2)
    v_xor_b32 v4, v100, v178
    v_xor_b32 v6, v101, v178
    v_add_f32 v5, v4, v6
    v_or_b32 v4, v4, v6
    v_cmp_ne_u32_sdwa vcc, v4, v200 src0_sel:BYTE_0 src1_sel:DWORD
    s_cbranch_vccnz L_rl47
L_ra48:
    v_mfma_f32_16x16x4_f32 v[120:123], v198, v5, v[144:147]
    s_nop 9
    v_cvt_pk_bf16_f32 v4, v120, v120
    buffer_store_short v4, v188, s[28:31], s86 offen sc0
    s_cmp_lg_u32 s6, 0
    s_cbranch_scc1 L_final
    buffer_store_short v4, v188, s[32:35], s86 offen sc1
    v_lshlrev_b32 v144, 16, v4
    s_branch L_next
L_final:
    s_endpgm
L_f1:
    s_cmp_lg_u32 s6, 0
    s_cbranch_scc1 L_p251
    v_lshlrev_b32 v12, 7, v1
    s_mov_b64 exec, 3
    buffer_load_dword v192, v12, s[8:11], s99 offen sc1
    s_mov_b64 exec, -1
    s_mul_i32 s83, s3, 73728
    s_lshl_b32 s84, s3, 10
    s_add_u32 m0, s84, 90112
    s_mov_b32 s86, 6
    s_add_u32 s83, s83, 1769472
L_fr53:
    s_cmp_ge_u32 s86, 18
    s_cbranch_scc1 L_fd54
    buffer_load_dwordx4 v162, s[24:27], s83 offen nt lds
    s_add_u32 s83, s83, 294912
    s_add_u32 m0, m0, 4096
    s_add_u32 s86, s86, 1
    s_branch L_fr53
L_fd54:
    s_waitcnt vmcnt(2)
    s_add_u32 s83, s87, 0
    buffer_load_dword v4, off, s[8:11], s83 sc1
    s_waitcnt vmcnt(1)
    s_barrier
    ds_read_b64_tr_b16 a[152:153], v163 offset:0
    ds_read_b64_tr_b16 a[154:155], v163 offset:256
    ds_read_b64_tr_b16 a[156:157], v163 offset:4096
    ds_read_b64_tr_b16 a[158:159], v163 offset:4352
    ds_read_b64_tr_b16 a[160:161], v163 offset:8192
    ds_read_b64_tr_b16 a[162:163], v163 offset:8448
    ds_read_b64_tr_b16 a[164:165], v163 offset:12288
    ds_read_b64_tr_b16 a[166:167], v163 offset:12544
    ds_read_b64_tr_b16 a[168:169], v163 offset:16384
    ds_read_b64_tr_b16 a[170:171], v163 offset:16640
    ds_read_b64_tr_b16 a[172:173], v163 offset:20480
    ds_read_b64_tr_b16 a[174:175], v163 offset:20736
    ds_read_b64_tr_b16 a[176:177], v163 offset:24576
    ds_read_b64_tr_b16 a[178:179], v163 offset:24832
    ds_read_b64_tr_b16 a[180:181], v163 offset:28672
    ds_read_b64_tr_b16 a[182:183], v163 offset:28928
    ds_read_b64_tr_b16 a[184:185], v163 offset:32768
    ds_read_b64_tr_b16 a[186:187], v163 offset:33024
    ds_read_b64_tr_b16 a[188:189], v163 offset:36864
    ds_read_b64_tr_b16 a[190:191], v163 offset:37120
    ds_read_b64_tr_b16 a[192:193], v163 offset:40960
    ds_read_b64_tr_b16 a[194:195], v163 offset:41216
    ds_read_b64_tr_b16 a[196:197], v163 offset:45056
    ds_read_b64_tr_b16 a[198:199], v163 offset:45312
    ds_read_b64_tr_b16 a[200:201], v163 offset:49152
    ds_read_b64_tr_b16 a[202:203], v163 offset:49408
    ds_read_b64_tr_b16 a[204:205], v163 offset:53248
    ds_read_b64_tr_b16 a[206:207], v163 offset:53504
    ds_read_b64_tr_b16 a[208:209], v163 offset:57344
    ds_read_b64_tr_b16 a[210:211], v163 offset:57600
    ds_read_b64_tr_b16 a[212:213], v163 offset:61440
    ds_read_b64_tr_b16 a[214:215], v163 offset:61696
    ds_read_b64_tr_b16 a[216:217], v164 offset:0
    ds_read_b64_tr_b16 a[218:219], v164 offset:256
    ds_read_b64_tr_b16 a[220:221], v164 offset:4096
    ds_read_b64_tr_b16 a[222:223], v164 offset:4352
    s_waitcnt lgkmcnt(0)
    s_waitcnt vmcnt(0)
    v_cmp_eq_u32 vcc, -1, v4
    s_cbranch_vccz L_f1go
L_p251:
    s_add_u32 s83, s87, 0
L_pw55:
    buffer_load_dword v4, off, s[8:11], s83 sc1
    s_sub_u32 s80, s80, 1
    s_cbranch_scc1 L_pd56
    s_waitcnt vmcnt(0)
    v_cmp_eq_u32 vcc, -1, v4
    s_cbranch_vccz L_pd56b
    s_sleep 2
    s_branch L_pw55
L_pd56:
    s_mov_b32 s80, 0
L_pd56b:
L_f1go:
    s_add_u32 s85, s87, 18432
L_x1s57:
    buffer_load_dwordx4 v[16:19], v185, s[8:11], s85 offen sc1
    buffer_load_dword v20, v186, s[8:11], s85 offen sc1
    s_sleep 2
L_x1l58:
    buffer_load_dwordx4 v[136:139], v185, s[8:11], s85 offen sc1
    buffer_load_dword v140, v186, s[8:11], s85 offen sc1
    s_sub_u32 s80, s80, 1
    s_cbranch_scc1 L_x1t61
    s_waitcnt vmcnt(2)
    v_max3_u32 v4, v16, v17, v18
    v_max3_u32 v4, v4, v19, v20
    v_cmp_eq_u32 vcc, -1, v4
    s_cbranch_vccz L_x1a59
    buffer_load_dwordx4 v[16:19], v185, s[8:11], s85 offen sc1
    buffer_load_dword v20, v186, s[8:11], s85 offen sc1
    s_waitcnt vmcnt(2)
    v_max3_u32 v4, v136, v137, v138
    v_max3_u32 v4, v4, v139, v140
    v_cmp_eq_u32 vcc, -1, v4
    s_cbranch_vccnz L_x1l58
    ds_write_b128 v165, v[136:139]
    ds_write_b32 v193, v140
    v_mov_b32 v16, v136
    v_mov_b32 v17, v137
    v_mov_b32 v18, v138
    v_mov_b32 v19, v139
    v_mov_b32 v20, v140
    s_branch L_x1d60
L_x1a59:
    ds_write_b128 v165, v[16:19]
    ds_write_b32 v193, v20
L_x1d60:
    s_mov_b64 exec, s[64:65]
    ds_read_b128 v[24:27], v166 offset:0
    ds_read_b128 v[28:31], v166 offset:128
    ds_read_b128 v[32:35], v166 offset:256
    ds_read_b128 v[36:39], v166 offset:384
    ds_read_b128 v[40:43], v166 offset:512
    ds_read_b128 v[44:47], v166 offset:640
    ds_read_b128 v[48:51], v166 offset:768
    ds_read_b128 v[52:55], v166 offset:896
    ds_read_b128 v[56:59], v166 offset:1024
    s_mov_b64 exec, -1
    v_mov_b32 v6, 0
    v_mov_b32 v7, 0
    v_dot2c_f32_bf16 v6, 0x3f803f80, v16
    v_dot2c_f32_bf16 v7, v16, v16
    v_dot2c_f32_bf16 v6, 0x3f803f80, v17
    v_dot2c_f32_bf16 v7, v17, v17
    v_dot2c_f32_bf16 v6, 0x3f803f80, v18
    v_dot2c_f32_bf16 v7, v18, v18
    v_dot2c_f32_bf16 v6, 0x3f803f80, v19
    v_dot2c_f32_bf16 v7, v19, v19
    v_dot2c_f32_bf16 v6, 0x3f803f80, v20
    v_dot2c_f32_bf16 v7, v20, v20
    s_waitcnt lgkmcnt(8)
    v_smfmac_f32_16x16x64_bf16 v[116:119], v[24:27], a[152:159], v174
    v_add_f32_dpp v6, v6, v6 row_ror:1 row_mask:0xf bank_mask:0xf
    v_add_f32_dpp v7, v7, v7 row_ror:1 row_mask:0xf bank_mask:0xf
    s_waitcnt lgkmcnt(7)
    v_smfmac_f32_16x16x64_bf16 v[116:119], v[28:31], a[160:167], v174
    v_add_f32_dpp v6, v6, v6 row_ror:2 row_mask:0xf bank_mask:0xf
    v_add_f32_dpp v7, v7, v7 row_ror:2 row_mask:0xf bank_mask:0xf
    s_waitcnt lgkmcnt(6)
    v_smfmac_f32_16x16x64_bf16 v[116:119], v[32:35], a[168:175], v174
    v_add_f32_dpp v6, v6, v6 row_ror:4 row_mask:0xf bank_mask:0xf
    v_add_f32_dpp v7, v7, v7 row_ror:4 row_mask:0xf bank_mask:0xf
    s_waitcnt lgkmcnt(5)
    v_smfmac_f32_16x16x64_bf16 v[116:119], v[36:39], a[176:183], v174
    v_add_f32_dpp v6, v6, v6 row_ror:8 row_mask:0xf bank_mask:0xf
    v_add_f32_dpp v7, v7, v7 row_ror:8 row_mask:0xf bank_mask:0xf
    s_waitcnt lgkmcnt(4)
    v_smfmac_f32_16x16x64_bf16 v[116:119], v[40:43], a[184:191], v174
    v_add_f32_dpp v6, v6, v6 row_bcast:15 row_mask:0xa bank_mask:0xf
    v_add_f32_dpp v7, v7, v7 row_bcast:15 row_mask:0xa bank_mask:0xf
    s_waitcnt lgkmcnt(3)
    v_smfmac_f32_16x16x64_bf16 v[116:119], v[44:47], a[192:199], v174
    v_add_f32_dpp v6, v6, v6 row_bcast:31 row_mask:0xc bank_mask:0xf
    v_add_f32_dpp v7, v7, v7 row_bcast:31 row_mask:0xc bank_mask:0xf
    s_waitcnt lgkmcnt(2)
    v_smfmac_f32_16x16x64_bf16 v[116:119], v[48:51], a[200:207], v174
    v_readlane_b32 s83, v6, 63
    v_readlane_b32 s84, v7, 63
    s_waitcnt lgkmcnt(1)
    v_smfmac_f32_16x16x64_bf16 v[116:119], v[52:55], a[208:215], v174
    v_mov_b32 v6, 0x3ae38e39
    v_mul_f32 v189, s83, v6
    s_waitcnt lgkmcnt(0)
    v_smfmac_f32_16x16x64_bf16 v[116:119], v[56:59], a[216:223], v174
    v_mul_f32 v7, s84, v6
    v_fma_f32 v7, -v189, v189, v7
    v_max_f32 v7, 0, v7
    v_add_f32 v7, 0x3727c5ac, v7
    v_rsq_f32 v190, v7
    s_nop 2
    v_add_f32 v4, v116, v117
    v_add_f32 v5, v118, v119
    v_fma_f32 v4, -v189, v5, v4
    v_fma_f32 v4, v190, v4, v191
    v_mul_f32 v5, 0xbfb8aa3b, v4
    v_min_f32 v5, v5, -v5
    v_exp_f32 v5, v5
    v_cmp_lt_f32 vcc, 0, v4
    s_add_u32 s85, s87, 20480
    v_mul_f32 v9, v5, v5
    v_cndmask_b32 v8, v9, 1.0, vcc
    v_cndmask_b32 v9, 1.0, v9, vcc
    v_fma_f32 v8, 2.0, v5, v8
    v_fma_f32 v9, 2.0, v9, v8
    v_rcp_f32 v9, v9
    v_mul_f32 v4, v4, v8
    v_mul_f32 v4, v4, v9
    v_cvt_pk_bf16_f32 v4, v4, v4
    buffer_store_short v4, v188, s[36:39], s85 offen sc0
    buffer_store_short v4, v188, s[32:35], s85 offen sc1
    s_branch L_next
L_f2:
    s_cmp_lg_u32 s6, 0
    s_cbranch_scc1 L_p262
    v_lshlrev_b32 v12, 7, v1
    s_mov_b64 exec, 3
    buffer_load_dword v192, v12, s[8:11], s99 offen sc1
    s_mov_b64 exec, -1
    s_add_u32 s83, s87, 23808
    buffer_load_dwordx2 v[12:13], v180, s[8:11], s83 offen sc1
    s_mul_i32 s83, s3, 9216
    s_lshl_b32 s84, s3, 10
    s_add_u32 m0, s84, 65536
    s_mov_b32 s86, 0
    s_add_u32 s83, s83, 0
L_fr64:
    s_cmp_ge_u32 s86, 18
    s_cbranch_scc1 L_fd65
    buffer_load_dwordx4 v162, s[24:27], s83 offen nt lds
    s_add_u32 s83, s83, 36864
    s_add_u32 m0, m0, 4096
    s_add_u32 s86, s86, 1
    s_branch L_fr64
L_fd65:
    s_waitcnt vmcnt(18)
    v_min_u32_dpp v12, v12, v12 row_ror:1 row_mask:0xf bank_mask:0xf
    v_min_u32_dpp v13, v13, v13 row_ror:1 row_mask:0xf bank_mask:0xf
    s_nop 0
    v_min_u32_dpp v12, v12, v12 row_ror:2 row_mask:0xf bank_mask:0xf
    v_min_u32_dpp v13, v13, v13 row_ror:2 row_mask:0xf bank_mask:0xf
    s_nop 0
    v_min_u32_dpp v12, v12, v12 row_ror:4 row_mask:0xf bank_mask:0xf
    v_min_u32_dpp v13, v13, v13 row_ror:4 row_mask:0xf bank_mask:0xf
    s_nop 0
    v_min_u32_dpp v12, v12, v12 row_ror:8 row_mask:0xf bank_mask:0xf
    v_min_u32_dpp v13, v13, v13 row_ror:8 row_mask:0xf bank_mask:0xf
    s_nop 0
    v_min_u32_dpp v12, v12, v12 row_bcast:15 row_mask:0xa bank_mask:0xf
    v_min_u32_dpp v13, v13, v13 row_bcast:15 row_mask:0xa bank_mask:0xf
    s_nop 0
    v_min_u32_dpp v12, v12, v12 row_bcast:31 row_mask:0xc bank_mask:0xf
    v_min_u32_dpp v13, v13, v13 row_bcast:31 row_mask:0xc bank_mask:0xf
    v_readlane_b32 s83, v12, 63
    v_readlane_b32 s84, v13, 63
    s_cmp_lt_u32 s84, s83
    s_cselect_b32 s91, 8192, 0
    s_lshl_b32 s97, s4, 11
    s_and_b32 s97, s97, 8192
    s_xor_b32 s97, s97, s91
    s_xor_b32 s98, s97, 8192
    s_add_u32 s97, s97, s90
    s_add_u32 s98, s98, s90
    s_waitcnt vmcnt(2)
    s_add_u32 s83, s87, 18432
    buffer_load_dword v4, off, s[8:11], s83 sc1
    s_waitcnt vmcnt(1)
    s_barrier
    ds_read_b64_tr_b16 a[152:153], v163 offset:0
    ds_read_b64_tr_b16 a[154:155], v163 offset:256
    ds_read_b64_tr_b16 a[156:157], v163 offset:4096
    ds_read_b64_tr_b16 a[158:159], v163 offset:4352
    ds_read_b64_tr_b16 a[160:161], v163 offset:8192
    ds_read_b64_tr_b16 a[162:163], v163 offset:8448
    ds_read_b64_tr_b16 a[164:165], v163 offset:12288
    ds_read_b64_tr_b16 a[166:167], v163 offset:12544
    ds_read_b64_tr_b16 a[168:169], v163 offset:16384
    ds_read_b64_tr_b16 a[170:171], v163 offset:16640
    ds_read_b64_tr_b16 a[172:173], v163 offset:20480
    ds_read_b64_tr_b16 a[174:175], v163 offset:20736
    ds_read_b64_tr_b16 a[176:177], v163 offset:24576
    ds_read_b64_tr_b16 a[178:179], v163 offset:24832
    ds_read_b64_tr_b16 a[180:181], v163 offset:28672
    ds_read_b64_tr_b16 a[182:183], v163 offset:28928
    ds_read_b64_tr_b16 a[184:185], v163 offset:32768
    ds_read_b64_tr_b16 a[186:187], v163 offset:33024
    ds_read_b64_tr_b16 a[188:189], v163 offset:36864
    ds_read_b64_tr_b16 a[190:191], v163 offset:37120
    ds_read_b64_tr_b16 a[192:193], v163 offset:40960
    ds_read_b64_tr_b16 a[194:195], v163 offset:41216
    ds_read_b64_tr_b16 a[196:197], v163 offset:45056
    ds_read_b64_tr_b16 a[198:199], v163 offset:45312
    ds_read_b64_tr_b16 a[200:201], v163 offset:49152
    ds_read_b64_tr_b16 a[202:203], v163 offset:49408
    ds_read_b64_tr_b16 a[204:205], v163 offset:53248
    ds_read_b64_tr_b16 a[206:207], v163 offset:53504
    ds_read_b64_tr_b16 a[208:209], v163 offset:57344
    ds_read_b64_tr_b16 a[210:211], v163 offset:57600
    ds_read_b64_tr_b16 a[212:213], v163 offset:61440
    ds_read_b64_tr_b16 a[214:215], v163 offset:61696
    ds_read_b64_tr_b16 a[216:217], v164 offset:0
    ds_read_b64_tr_b16 a[218:219], v164 offset:256
    ds_read_b64_tr_b16 a[220:221], v164 offset:4096
    ds_read_b64_tr_b16 a[222:223], v164 offset:4352
    s_waitcnt lgkmcnt(0)
    s_waitcnt vmcnt(0)
    v_cmp_eq_u32 vcc, -1, v4
    s_cbranch_vccz L_f2go
L_p262:
    s_lshl_b32 s97, s4, 11
    s_and_b32 s97, s97, 8192
    s_xor_b32 s97, s97, s91
    s_xor_b32 s98, s97, 8192
    s_add_u32 s97, s97, s90
    s_add_u32 s98, s98, s90
    s_add_u32 s83, s87, 18432
L_pw66:
    buffer_load_dword v4, off, s[8:11], s83 sc1
    s_sub_u32 s80, s80, 1
    s_cbranch_scc1 L_pd67
    s_waitcnt vmcnt(0)
    v_cmp_eq_u32 vcc, -1, v4
    s_cbranch_vccz L_pd67b
    s_sleep 2
    s_branch L_pw66
L_pd67:
    s_mov_b32 s80, 0
L_pd67b:
L_f2go:
    s_add_u32 s85, s87, 20480
L_acs68:
    buffer_load_dwordx4 v[16:19], v185, s[8:11], s85 offen sc1
    buffer_load_dword v20, v186, s[8:11], s85 offen sc1
    s_sleep 2
L_acl69:
    buffer_load_dwordx4 v[136:139], v185, s[8:11], s85 offen sc1
    buffer_load_dword v140, v186, s[8:11], s85 offen sc1
    s_sub_u32 s80, s80, 1
    s_cbranch_scc1 L_act72
    s_waitcnt vmcnt(2)
    v_max3_u32 v4, v16, v17, v18
    v_max3_u32 v4, v4, v19, v20
    v_cmp_eq_u32 vcc, -1, v4
    s_cbranch_vccz L_aca70
    buffer_load_dwordx4 v[16:19], v185, s[8:11], s85 offen sc1
    buffer_load_dword v20, v186, s[8:11], s85 offen sc1
    s_waitcnt vmcnt(2)
    v_max3_u32 v4, v136, v137, v138
    v_max3_u32 v4, v4, v139, v140
    v_cmp_eq_u32 vcc, -1, v4
    s_cbranch_vccnz L_acl69
    ds_write_b128 v165, v[136:139]
    ds_write_b32 v193, v140
    s_branch L_acd71
L_aca70:
    ds_write_b128 v165, v[16:19]
    ds_write_b32 v193, v20
L_acd71:
    s_mov_b64 exec, s[64:65]
    ds_read_b128 v[24:27], v166 offset:0
    ds_read_b128 v[28:31], v166 offset:128
    ds_read_b128 v[32:35], v166 offset:256
    ds_read_b128 v[36:39], v166 offset:384
    ds_read_b128 v[40:43], v166 offset:512
    ds_read_b128 v[44:47], v166 offset:640
    ds_read_b128 v[48:51], v166 offset:768
    ds_read_b128 v[52:55], v166 offset:896
    ds_read_b128 v[56:59], v166 offset:1024
    s_mov_b64 exec, -1
    s_waitcnt lgkmcnt(8)
    v_smfmac_f32_16x16x64_bf16 v[116:119], v[24:27], a[152:159], v174
    s_waitcnt lgkmcnt(7)
    v_smfmac_f32_16x16x64_bf16 v[116:119], v[28:31], a[160:167], v174
    s_waitcnt lgkmcnt(6)
    v_smfmac_f32_16x16x64_bf16 v[116:119], v[32:35], a[168:175], v174
    s_waitcnt lgkmcnt(5)
    v_smfmac_f32_16x16x64_bf16 v[116:119], v[36:39], a[176:183], v174
    s_waitcnt lgkmcnt(4)
    v_smfmac_f32_16x16x64_bf16 v[116:119], v[40:43], a[184:191], v174
    s_waitcnt lgkmcnt(3)
    v_smfmac_f32_16x16x64_bf16 v[116:119], v[44:47], a[192:199], v174
    s_waitcnt lgkmcnt(2)
    v_smfmac_f32_16x16x64_bf16 v[116:119], v[48:51], a[200:207], v174
    s_waitcnt lgkmcnt(1)
    v_smfmac_f32_16x16x64_bf16 v[116:119], v[52:55], a[208:215], v174
    s_waitcnt lgkmcnt(0)
    v_smfmac_f32_16x16x64_bf16 v[116:119], v[56:59], a[216:223], v174
    s_nop 7
    v_add_f32 v4, v116, v117
    v_bfi_b32 v4, s81, v178, v4
    buffer_store_dword v4, v156, s[8:11], s97 offen sc1
    buffer_store_dword v4, v157, s[8:11], s98 offen sc1
    buffer_store_dword v4, v156, s[8:11], s98 offen sc1
    buffer_store_dword v4, v157, s[8:11], s97 offen sc1
    s_branch L_next
L_idle:
    s_cmp_lg_u32 s6, 0
    s_cbranch_scc1 L_exit
    s_add_u32 s83, s87, 23808
    buffer_load_dwordx2 v[10:11], v180, s[8:11], s83 offen sc1
    s_waitcnt vmcnt(0)
    v_min_u32_dpp v10, v10, v10 row_ror:1 row_mask:0xf bank_mask:0xf
    v_min_u32_dpp v11, v11, v11 row_ror:1 row_mask:0xf bank_mask:0xf
    s_nop 0
    v_min_u32_dpp v10, v10, v10 row_ror:2 row_mask:0xf bank_mask:0xf
    v_min_u32_dpp v11, v11, v11 row_ror:2 row_mask:0xf bank_mask:0xf
    s_nop 0
    v_min_u32_dpp v10, v10, v10 row_ror:4 row_mask:0xf bank_mask:0xf
    v_min_u32_dpp v11, v11, v11 row_ror:4 row_mask:0xf bank_mask:0xf
    s_nop 0
    v_min_u32_dpp v10, v10, v10 row_ror:8 row_mask:0xf bank_mask:0xf
    v_min_u32_dpp v11, v11, v11 row_ror:8 row_mask:0xf bank_mask:0xf
    s_nop 0
    v_min_u32_dpp v10, v10, v10 row_bcast:15 row_mask:0xa bank_mask:0xf
    v_min_u32_dpp v11, v11, v11 row_bcast:15 row_mask:0xa bank_mask:0xf
    s_nop 0
    v_min_u32_dpp v10, v10, v10 row_bcast:31 row_mask:0xc bank_mask:0xf
    v_min_u32_dpp v11, v11, v11 row_bcast:31 row_mask:0xc bank_mask:0xf
    v_readlane_b32 s83, v10, 63
    v_readlane_b32 s84, v11, 63
    s_cmp_lt_u32 s84, s83
    s_cselect_b32 s91, 8192, 0
    s_lshl_b32 s83, s92, 3
    s_mul_i32 s84, s4, 144
    s_add_u32 s83, s83, s84
    v_add_lshl_u32 v4, v1, s83, 7
    v_lshrrev_b32 v6, 13, v4
    v_lshl_add_u32 v4, v6, 13, v4
    s_add_u32 s83, s91, s90
    s_cmp_lt_u32 s92, 18
    s_cselect_b64 exec, 0xff, 0
    s_cbranch_execz L_not
    buffer_load_dword v192, v4, s[8:11], s83 offen sc1
L_not:
    s_mov_b64 exec, -1
    s_mul_i32 s83, s4, 1152
    s_add_u32 s28, s44, s83
    s_addc_u32 s29, s45, 0
    s_mov_b32 s30, 5300352
    s_lshr_b32 s83, s28, 7
    s_sub_u32 s83, 3, s83
    s_and_b32 s83, s83, 7
    s_lshl_b32 s83, s83, 7
    s_mul_i32 s84, s92, 20
    s_add_u32 s84, s84, 192
    v_and_b32 v4, 31, v1
    v_add_u32 v5, s84, v4
    v_mul_u32_u24 v5, 9216, v5
    v_lshrrev_b32 v6, 5, v1
    v_lshl_add_u32 v5, v6, 10, v5
    s_cmp_eq_u32 s83, 0
    s_cselect_b32 exec_hi, 1048575, 0
    s_mov_b32 exec_lo, 1048575
    buffer_load_dword v192, v5, s[28:31], s83 offen
    s_mov_b64 exec, -1
    v_lshlrev_b32 v12, 7, v1
    s_mov_b64 exec, 3
    buffer_load_dword v192, v12, s[8:11], s99 offen sc1
    s_mov_b64 exec, -1
L_next:
    s_cmp_lg_u32 s6, 0
    s_cbranch_scc1 L_exit
    s_mov_b32 s6, 1
    s_add_u32 s87, s87, 49152
    s_add_u32 s88, s88, 40960
    s_add_u32 s89, s89, 40960
    s_add_u32 s90, s90, 589824
    s_branch L_top
L_c113:
    s_lshl_b32 s85, s3, 14
    v_add_f32 v149, v118, v119
    v_bfi_b32 v149, s81, v178, v149
    s_add_u32 s83, s88, 8192
    buffer_store_dword v149, v179, s[8:11], s83 offen
    s_waitcnt lgkmcnt(0)
    v_mov_b32 v6, 0
    v_mov_b32 v7, 0
    v_dot2c_f32_bf16 v6, 0x3f803f80, v16
    v_dot2c_f32_bf16 v7, v16, v16
    v_dot2c_f32_bf16 v6, 0x3f803f80, v17
    v_dot2c_f32_bf16 v7, v17, v17
    v_dot2c_f32_bf16 v6, 0x3f803f80, v18
    v_dot2c_f32_bf16 v7, v18, v18
    v_dot2c_f32_bf16 v6, 0x3f803f80, v19
    v_dot2c_f32_bf16 v7, v19, v19
    v_dot2c_f32_bf16 v6, 0x3f803f80, v20
    v_dot2c_f32_bf16 v7, v20, v20
    s_nop 1
    v_add_f32_dpp v6, v6, v6 row_ror:1 row_mask:0xf bank_mask:0xf
    v_add_f32_dpp v7, v7, v7 row_ror:1 row_mask:0xf bank_mask:0xf
    s_nop 0
    v_add_f32_dpp v6, v6, v6 row_ror:2 row_mask:0xf bank_mask:0xf
    v_add_f32_dpp v7, v7, v7 row_ror:2 row_mask:0xf bank_mask:0xf
    s_nop 0
    v_add_f32_dpp v6, v6, v6 row_ror:4 row_mask:0xf bank_mask:0xf
    v_add_f32_dpp v7, v7, v7 row_ror:4 row_mask:0xf bank_mask:0xf
    s_nop 0
    v_add_f32_dpp v6, v6, v6 row_ror:8 row_mask:0xf bank_mask:0xf
    v_add_f32_dpp v7, v7, v7 row_ror:8 row_mask:0xf bank_mask:0xf
    s_nop 0
    v_add_f32_dpp v6, v6, v6 row_bcast:15 row_mask:0xa bank_mask:0xf
    v_add_f32_dpp v7, v7, v7 row_bcast:15 row_mask:0xa bank_mask:0xf
    s_nop 0
    v_add_f32_dpp v6, v6, v6 row_bcast:31 row_mask:0xc bank_mask:0xf
    v_add_f32_dpp v7, v7, v7 row_bcast:31 row_mask:0xc bank_mask:0xf
    v_readlane_b32 s83, v6, 63
    v_readlane_b32 s84, v7, 63
    v_mov_b32 v6, 0x3ae38e39
    v_mul_f32 v189, s83, v6
    v_mul_f32 v7, s84, v6
    v_fma_f32 v7, -v189, v189, v7
    v_max_f32 v7, 0, v7
    v_add_f32 v7, 0x3727c5ac, v7
    v_rsq_f32 v190, v7
    v_mov_b32 v116, 0
    v_mov_b32 v117, 0
    v_mov_b32 v118, 0
    v_mov_b32 v119, 0
    v_mov_b32 v120, 0
    v_mov_b32 v121, 0
    v_mov_b32 v122, 0
    v_mov_b32 v123, 0
    v_mul_f32 v199, v189, v190
    v_mul_f32 v199, -v199, v196
    s_add_u32 m0, s85, 79872
    s_nop 0
    buffer_load_dwordx4 v110, s[12:15], s82 offen nt lds
    s_add_u32 s82, s82, 4096
    s_and_b32 s82, s82, 65535
    s_add_u32 m0, s85, 80896
    s_nop 0
    buffer_load_dwordx4 v111, s[12:15], s82 offen nt lds
    s_add_u32 s82, s82, 4096
    s_and_b32 s82, s82, 65535
    s_add_u32 m0, s85, 0
    s_nop 0
    buffer_load_dwordx4 v124, s[16:19], s82 offen nt lds
    s_add_u32 s82, s82, 4096
    s_and_b32 s82, s82, 65535
    v_add_u32 v4, 0, v3
    v_mul_u32_u24 v4, 36, v4
    s_and_b32 s84, s92, -1
    v_add_u32 v4, s84, v4
    s_lshl_b32 s83, s4, 6
    s_and_b32 s84, s92, 0
    s_lshl_b32 s84, s84, 6
    s_add_u32 s83, s83, s84
    v_lshl_add_u32 v5, v2, 2, s83
    v_lshl_add_u32 v5, v4, 9, v5
    v_lshrrev_b32 v9, 13, v5
    v_lshlrev_b32 v9, 13, v9
    v_add_u32 v156, v9, v5
    v_mov_b32 v158, v156
    v_add_u32 v156, 294912, v156
    v_add_u32 v4, 4, v3
    v_mul_u32_u24 v4, 36, v4
    s_and_b32 s84, s92, -1
    v_add_u32 v4, s84, v4
    s_lshl_b32 s83, s4, 6
    s_and_b32 s84, s92, 0
    s_lshl_b32 s84, s84, 6
    s_add_u32 s83, s83, s84
    v_lshl_add_u32 v5, v2, 2, s83
    v_lshl_add_u32 v5, v4, 9, v5
    v_lshrrev_b32 v9, 13, v5
    v_lshlrev_b32 v9, 13, v9
    v_add_u32 v157, v9, v5
    v_mov_b32 v159, v157
    v_add_u32 v157, 294912, v157
    s_mul_i32 s83, s4, 36
    s_add_u32 s83, s83, s92
    s_lshl_b32 s83, s83, 9
    v_and_b32 v4, 63, v1
    v_lshl_add_u32 v4, v4, 2, s83
    v_lshrrev_b32 v9, 13, v4
    v_lshlrev_b32 v9, 13, v9
    v_add_u32 v201, v9, v4
    v_mov_b32 v198, 1.0
    v_mov_b32 v145, 0
    v_mov_b32 v146, 0
    v_mov_b32 v147, 0
    v_mov_b32 v187, v201
    v_add_u32 v201, 294912, v201
    s_add_u32 s90, s54, 0x1fffff
    s_and_b32 s90, s90, 0xffe00000
    s_sub_u32 s90, s90, s54
    s_add_u32 s90, s90, 2097152
    s_mov_b32 s91, 0
    v_readfirstlane_b32 s83, v187
    s_add_u32 s83, s83, s90
    s_add_u32 s66, s54, s83
    s_addc_u32 s67, s55, 0
    s_mov_b32 s97, -1
    s_mov_b32 s98, -1
    s_cmp_lg_u32 s73, 3
    s_cbranch_scc1 L_nowup
    s_load_dword s95, s[66:67], 0 glc
    s_load_dword s96, s[66:67], 8192 glc
L_nowup:
    v_mov_b32 v36, 0x3f803f80
    v_mov_b32 v37, 0x3f803f80
    v_mov_b32 v38, 0x3f803f80
    v_mov_b32 v39, 0x3f803f80
    v_mov_b32 v40, 0x3f803f80
    v_mov_b32 v41, 0x3f803f80
    v_mov_b32 v42, 0x3f803f80
    v_mov_b32 v43, 0x3f803f80
    v_mov_b32 v44, 0x3f803f80
    v_mov_b32 v45, 0x3f803f80
    v_mov_b32 v46, 0x3f803f80
    v_mov_b32 v47, 0x3f803f80
    v_mov_b32 v48, 0x3f803f80
    v_mov_b32 v49, 0x3f803f80
    v_mov_b32 v50, 0x3f803f80
    v_mov_b32 v51, 0x3f803f80
    v_mov_b32 v52, 0x3f803f80
    v_mov_b32 v53, 0x3f803f80
    v_mov_b32 v54, 0x3f803f80
    v_mov_b32 v55, 0x3f803f80
    v_mov_b32 v56, 0x3f803f80
    v_mov_b32 v57, 0x3f803f80
    v_mov_b32 v58, 0x3f803f80
    v_mov_b32 v59, 0x3f803f80
    v_mov_b32 v60, 0
    v_mov_b32 v61, 0
    v_mov_b32 v62, 0
    v_mov_b32 v63, 0
    v_mov_b32 v64, 0
    v_mov_b32 v65, 0
    v_mov_b32 v66, 0
    v_mov_b32 v67, 0
    v_mov_b32 v68, 0
    v_mov_b32 v69, 0
    v_mov_b32 v70, 0
    v_mov_b32 v71, 0
    v_mov_b32 v72, 0
    v_mov_b32 v73, 0
    v_mov_b32 v74, 0
    v_mov_b32 v75, 0
    v_mov_b32 v76, 0
    v_mov_b32 v77, 0
    v_mov_b32 v78, 0
    v_mov_b32 v79, 0
    v_mov_b32 v80, 0
    v_mov_b32 v81, 0
    v_mov_b32 v82, 0
    v_mov_b32 v83, 0
    v_mov_b32 v84, 0
    v_mov_b32 v85, 0
    v_mov_b32 v86, 0
    v_mov_b32 v87, 0
    v_mov_b32 v88, 0
    v_mov_b32 v89, 0
    v_mov_b32 v90, 0
    v_mov_b32 v91, 0
    s_waitcnt vmcnt(12)
    ds_read_b128 a[0:3], v112 offset:0
    ds_read_b128 a[4:7], v113 offset:0
    ds_read_b128 a[8:11], v114 offset:0
    ds_read_b128 a[12:15], v115 offset:0
    ds_read_b128 a[16:19], v112 offset:4096
    ds_read_b128 a[20:23], v113 offset:4096
    ds_read_b128 a[24:27], v114 offset:4096
    ds_read_b128 a[28:31], v115 offset:4096
    v_lshlrev_b32 v191, 16, v191
    v_lshlrev_b32 v144, 16, v132
    s_add_u32 m0, s85, 1024
    s_nop 0
    buffer_load_dwordx4 v125, s[16:19], s82 offen nt lds
    s_add_u32 s82, s82, 4096
    s_and_b32 s82, s82, 65535
    s_add_u32 m0, s85, 2048
    s_nop 0
    buffer_load_dwordx4 v126, s[16:19], s82 offen nt lds
    s_add_u32 s82, s82, 4096
    s_and_b32 s82, s82, 65535
    s_add_u32 m0, s85, 3072
    s_nop 0
    buffer_load_dwordx4 v127, s[16:19], s82 offen nt lds
    s_add_u32 s82, s82, 4096
    s_and_b32 s82, s82, 65535
    s_lshl_b32 s86, s4, 7
    s_add_u32 s86, s86, 4096
    buffer_load_dword v131, v130, s[8:11], s86 offen sc1
    buffer_load_dword v92, v197, s[8:11], s89 offen offset:0 sc1
    buffer_load_dword v93, v197, s[8:11], s89 offen offset:256 sc1
    buffer_load_dword v94, v197, s[8:11], s89 offen offset:512 sc1
    buffer_load_dword v95, v197, s[8:11], s89 offen offset:768 sc1
    s_add_u32 s83, s89, 8192
    buffer_load_dword v96, v197, s[8:11], s83 offen offset:0 sc1
    buffer_load_dword v97, v197, s[8:11], s83 offen offset:256 sc1
    buffer_load_dword v98, v197, s[8:11], s83 offen offset:512 sc1
    buffer_load_dword v99, v197, s[8:11], s83 offen offset:768 sc1
    v_lshlrev_b32 v4, 7, v1
    s_mov_b64 exec, 3
    buffer_load_dword v192, v4, s[8:11], s99 offen sc1
    s_mov_b64 exec, -1
    s_add_u32 m0, s85, 4096
    s_nop 0
    buffer_load_dwordx4 v124, s[16:19], s82 offen nt lds
    s_add_u32 s82, s82, 4096
    s_and_b32 s82, s82, 65535
    s_waitcnt vmcnt(22)
    ds_read_b128 a[32:35], v112 offset:8192
    ds_read_b128 a[36:39], v113 offset:8192
    ds_read_b128 a[40:43], v114 offset:8192
    ds_read_b128 a[44:47], v115 offset:8192
    s_add_u32 m0, s85, 5120
    s_nop 0
    buffer_load_dwordx4 v125, s[16:19], s82 offen nt lds
    s_add_u32 s82, s82, 4096
    s_and_b32 s82, s82, 65535
    s_add_u32 m0, s85, 6144
    s_nop 0
    buffer_load_dwordx4 v126, s[16:19], s82 offen nt lds
    s_add_u32 s82, s82, 4096
    s_and_b32 s82, s82, 65535
    s_add_u32 m0, s85, 7168
    s_nop 0
    buffer_load_dwordx4 v127, s[16:19], s82 offen nt lds
    s_add_u32 s82, s82, 4096
    s_and_b32 s82, s82, 65535
    s_add_u32 m0, s85, 8192
    s_nop 0
    buffer_load_dwordx4 v124, s[16:19], s82 offen nt lds
    s_add_u32 s82, s82, 4096
    s_and_b32 s82, s82, 65535
    s_waitcnt vmcnt(19)
    ds_read_b128 a[48:51], v112 offset:12288
    ds_read_b128 a[52:55], v113 offset:12288
    ds_read_b128 a[56:59], v114 offset:12288
    ds_read_b128 a[60:63], v115 offset:12288
    s_add_u32 m0, s85, 9216
    s_nop 0
    buffer_load_dwordx4 v125, s[16:19], s82 offen nt lds
    s_add_u32 s82, s82, 4096
    s_and_b32 s82, s82, 65535
    s_add_u32 m0, s85, 10240
    s_nop 0
    buffer_load_dwordx4 v126, s[16:19], s82 offen nt lds
    s_add_u32 s82, s82, 4096
    s_and_b32 s82, s82, 65535
    s_add_u32 m0, s85, 11264
    s_nop 0
    buffer_load_dwordx4 v127, s[16:19], s82 offen nt lds
    s_add_u32 s82, s82, 4096
    s_and_b32 s82, s82, 65535
    s_cmp_lg_u32 s73, 3
    s_cbranch_scc1 L_ci14
    s_and_b32 s83, s3, 1
    s_lshl_b32 s83, s83, 13
    s_waitcnt lgkmcnt(0)
    s_memtime s[68:69]
    s_load_dword s95, s[66:67], s83 glc
    s_waitcnt lgkmcnt(0)
    s_mov_b32 s83, s68
    s_memtime s[68:69]
    s_waitcnt lgkmcnt(0)
    s_sub_u32 s83, s68, s83
    s_bitcmp1_b32 s3, 0
    s_cselect_b32 s97, s97, s83
    s_cselect_b32 s98, s83, s98
L_ci14:
    s_waitcnt vmcnt(9)
    s_branch L_hec16
L_hel15:
    buffer_load_dword v131, v130, s[8:11], s86 offen sc1
    s_sub_u32 s80, s80, 1
    s_cbranch_scc1 L_her18
    s_waitcnt vmcnt(0)
L_hec16:
    v_xor_b32 v10, s75, v131
    v_cmp_lt_u32 vcc, 15, v10
    s_cbranch_vccnz L_hel15
L_hed17:
    v_cmp_ne_u32 vcc, s79, v131
    s_cmp_eq_u64 vcc, 0
    s_cselect_b32 s7, 1, 0
    s_cbranch_scc1 L_samedie
    s_mov_b32 s38, 0
    s_mov_b32 s34, 8388608
    buffer_store_dwordx4 v[136:139], v133, s[8:11], s99 offen sc1
    s_waitcnt vmcnt(0)
    s_lshl_b32 s83, s4, 7
    s_lshl_b32 s84, s5, 2
    s_add_u32 s83, s83, s84
    s_add_u32 s83, s83, 36864
    v_mov_b32 v10, s79
    v_mov_b32 v11, 1073741824
    v_lshlrev_b32 v12, 2, v0
    v_cmp_gt_u32 vcc, 1, v0
    s_nop 1
    v_cndmask_b32 v11, v11, v12, vcc
    s_barrier
    buffer_store_dword v10, v11, s[8:11], s83 offen sc1
    s_add_u32 s86, s86, 0x8000
L_h2l19:
    buffer_load_dword v131, v130, s[8:11], s86 offen sc1
    s_sub_u32 s80, s80, 1
    s_cbranch_scc1 L_h2r22
    s_waitcnt vmcnt(0)
L_h2c20:
    v_xor_b32 v10, s75, v131
    v_cmp_lt_u32 vcc, 15, v10
    s_cbranch_vccnz L_h2l19
L_h2d21:
    buffer_store_dword v148, v179, s[8:11], s88 offen sc1
    s_add_u32 s83, s88, 8192
    buffer_store_dword v149, v179, s[8:11], s83 offen sc1
L_samedie:
    v_xor_b32 v4, v92, v178
    v_bitop3_b32 v4, v93, v178, v4 bitop3:0xbe
    v_bitop3_b32 v4, v94, v178, v4 bitop3:0xbe
    v_bitop3_b32 v4, v95, v178, v4 bitop3:0xbe
    v_bitop3_b32 v4, v96, v178, v4 bitop3:0xbe
    v_bitop3_b32 v4, v97, v178, v4 bitop3:0xbe
    v_bitop3_b32 v4, v98, v178, v4 bitop3:0xbe
    v_bitop3_b32 v4, v99, v178, v4 bitop3:0xbe
    v_cmp_ne_u32_sdwa vcc, v4, v200 src0_sel:BYTE_0 src1_sel:DWORD
    s_mov_b32 s93, 0
    s_cbranch_vccz L_h1ok
    s_mov_b32 s93, 1
    buffer_load_dword v92, v197, s[8:11], s89 offen offset:0 sc1
    buffer_load_dword v93, v197, s[8:11], s89 offen offset:256 sc1
    buffer_load_dword v94, v197, s[8:11], s89 offen offset:512 sc1
    buffer_load_dword v95, v197, s[8:11], s89 offen offset:768 sc1
    s_add_u32 s83, s89, 8192
    buffer_load_dword v96, v197, s[8:11], s83 offen offset:0 sc1
    buffer_load_dword v97, v197, s[8:11], s83 offen offset:256 sc1
    buffer_load_dword v98, v197, s[8:11], s83 offen offset:512 sc1
    buffer_load_dword v99, v197, s[8:11], s83 offen offset:768 sc1
L_h1ok:
    s_add_u32 s99, s99, 49152
    buffer_store_dwordx4 v[136:139], v133, s[36:39], s99 offen sc0
    buffer_store_dwordx4 v[136:139], v133, s[32:35], s99 offen sc1
    s_cmp_lg_u32 s73, 3
    s_cbranch_scc1 L_cp23
    v_mov_b32 v4, s97
    v_mov_b32 v5, s98
    s_lshl_b32 s83, s92, 3
    s_add_u32 s83, s83, s87
    s_add_u32 s83, s83, 23808
    s_mov_b64 exec, 1
    buffer_store_dwordx2 v[4:5], off, s[36:39], s83 sc0
    buffer_store_dwordx2 v[4:5], off, s[32:35], s83 sc1
    s_mov_b64 exec, -1
L_cp23:
    s_add_u32 m0, s85, 12288
    s_nop 0
    buffer_load_dwordx4 v124, s[16:19], s82 offen nt lds
    s_add_u32 s82, s82, 4096
    s_and_b32 s82, s82, 65535
    s_add_u32 m0, s85, 13312
    s_nop 0
    buffer_load_dwordx4 v125, s[16:19], s82 offen nt lds
    s_add_u32 s82, s82, 4096
    s_and_b32 s82, s82, 65535
    s_add_u32 m0, s85, 14336
    s_nop 0
    buffer_load_dwordx4 v126, s[16:19], s82 offen nt lds
    s_add_u32 s82, s82, 4096
    s_and_b32 s82, s82, 65535
    s_add_u32 m0, s85, 15360
    s_nop 0
    buffer_load_dwordx4 v127, s[16:19], s82 offen nt lds
    s_add_u32 s82, s82, 4096
    s_and_b32 s82, s82, 65535
    s_and_b32 s83, s73, 0
    s_lshl2_add_u32 s83, s4, s83
    s_mul_i32 s83, s83, 147456
    s_lshl_b32 s86, s74, 7
    s_add_u32 s83, s83, s86
    s_add_u32 s20, s40, s83
    s_addc_u32 s21, s41, 0
    s_mov_b32 s22, 588800
    s_cmp_eq_u32 s93, 0
    s_cbranch_scc1 L_h1ok2
    s_waitcnt vmcnt(4)
L_h1ok2:
    s_branch L_hqc25
L_hql24:
    buffer_load_dword v92, v197, s[8:11], s89 offen offset:0 sc1
    buffer_load_dword v93, v197, s[8:11], s89 offen offset:256 sc1
    buffer_load_dword v94, v197, s[8:11], s89 offen offset:512 sc1
    buffer_load_dword v95, v197, s[8:11], s89 offen offset:768 sc1
    s_add_u32 s83, s89, 8192
    buffer_load_dword v96, v197, s[8:11], s83 offen offset:0 sc1
    buffer_load_dword v97, v197, s[8:11], s83 offen offset:256 sc1
    buffer_load_dword v98, v197, s[8:11], s83 offen offset:512 sc1
    buffer_load_dword v99, v197, s[8:11], s83 offen offset:768 sc1
    s_sub_u32 s80, s80, 1
    s_cbranch_scc1 L_hqr27
    s_waitcnt vmcnt(0)
L_hqc25:
    v_xor_b32 v4, v92, v178
    v_bitop3_b32 v4, v93, v178, v4 bitop3:0xbe
    v_bitop3_b32 v4, v94, v178, v4 bitop3:0xbe
    v_bitop3_b32 v4, v95, v178, v4 bitop3:0xbe
    v_bitop3_b32 v4, v96, v178, v4 bitop3:0xbe
    v_bitop3_b32 v4, v97, v178, v4 bitop3:0xbe
    v_bitop3_b32 v4, v98, v178, v4 bitop3:0xbe
    v_bitop3_b32 v4, v99, v178, v4 bitop3:0xbe
    v_cmp_ne_u32_sdwa vcc, v4, v200 src0_sel:BYTE_0 src1_sel:DWORD
    s_cbranch_vccnz L_hql24
L_hqd26:
    v_xor_b32 v92, v92, v178
    v_xor_b32 v93, v93, v178
    v_xor_b32 v94, v94, v178
    v_xor_b32 v95, v95, v178
    v_xor_b32 v96, v96, v178
    v_xor_b32 v97, v97, v178
    v_xor_b32 v98, v98, v178
    v_xor_b32 v99, v99, v178
    s_mov_b32 s101, 0
    v_add_f32 v196, v96, v97
    v_add_f32 v4, v98, v99
    v_add_f32 v196, v196, v4
    v_mul_f32 v199, v189, v190
    v_mul_f32 v199, -v199, v196
    s_branch L_h1a10
L_no29:
    s_waitcnt vmcnt(10)
    s_barrier
    ds_read_b64_tr_b16 a[64:65], v154 offset:0
    ds_read_b64_tr_b16 a[66:67], v154 offset:512
    ds_read_b64_tr_b16 a[72:73], v155 offset:0
    ds_read_b64_tr_b16 a[74:75], v155 offset:512
    ds_read_b64_tr_b16 a[80:81], v154 offset:16384
    ds_read_b64_tr_b16 a[82:83], v154 offset:16896
    ds_read_b64_tr_b16 a[88:89], v155 offset:16384
    ds_read_b64_tr_b16 a[90:91], v155 offset:16896
    ds_read_b64_tr_b16 a[96:97], v154 offset:32768
    ds_read_b64_tr_b16 a[98:99], v154 offset:33280
    ds_read_b64_tr_b16 a[104:105], v155 offset:32768
    ds_read_b64_tr_b16 a[106:107], v155 offset:33280
    ds_read_b64_tr_b16 a[112:113], v154 offset:49152
    ds_read_b64_tr_b16 a[114:115], v154 offset:49664
    ds_read_b64_tr_b16 a[120:121], v155 offset:49152
    ds_read_b64_tr_b16 a[122:123], v155 offset:49664
    s_cmp_lg_u32 s73, 0
    s_cbranch_scc1 L_no29a
    s_add_u32 s83, s87, 23808
    buffer_load_dwordx2 v[152:153], v180, s[8:11], s83 offen sc1
    s_mul_i32 s83, s3, 9216
    s_lshl_b32 s84, s3, 10
    s_add_u32 m0, s84, 65536
    s_nop 0
    buffer_load_dwordx4 v202, s[20:23], s83 offen nt lds
    s_add_u32 s83, s83, 36864
    s_add_u32 m0, m0, 4096
    s_nop 0
    buffer_load_dwordx4 v202, s[20:23], s83 offen nt lds
    s_add_u32 s83, s83, 36864
    s_add_u32 m0, m0, 4096
    s_nop 0
    buffer_load_dwordx4 v202, s[20:23], s83 offen nt lds
    s_add_u32 s83, s83, 36864
    s_add_u32 m0, m0, 4096
    s_nop 0
    buffer_load_dwordx4 v202, s[20:23], s83 offen nt lds
    s_add_u32 s83, s83, 36864
    s_add_u32 m0, m0, 4096
    s_nop 0
    buffer_load_dwordx4 v202, s[20:23], s83 offen nt lds
    s_add_u32 s83, s83, 36864
    s_add_u32 m0, m0, 4096
    s_nop 0
    buffer_load_dwordx4 v202, s[20:23], s83 offen nt lds
    s_add_u32 s83, s83, 36864
    s_add_u32 m0, m0, 4096
    s_nop 0
    buffer_load_dwordx4 v202, s[20:23], s83 offen nt lds
    s_add_u32 s83, s83, 36864
    s_add_u32 m0, m0, 4096
    s_nop 0
    buffer_load_dwordx4 v202, s[20:23], s83 offen nt lds
    s_add_u32 s83, s83, 36864
    s_add_u32 m0, m0, 4096
    s_nop 0
    buffer_load_dwordx4 v202, s[20:23], s83 offen nt lds
    s_waitcnt vmcnt(9)
    s_branch L_no29b
L_no29a:
    s_cmp_lg_u32 s73, 1
    s_cbranch_scc1 L_no29r1
    s_mul_i32 s83, s3, 73728
    s_lshl_b32 s84, s3, 10
    s_add_u32 m0, s84, 65536
    s_nop 0
    buffer_load_dwordx4 v162, s[24:27], s83 offen nt lds
    s_add_u32 s83, s83, 294912
    s_add_u32 m0, m0, 4096
    s_nop 0
    buffer_load_dwordx4 v162, s[24:27], s83 offen nt lds
    s_add_u32 s83, s83, 294912
    s_add_u32 m0, m0, 4096
    s_nop 0
    buffer_load_dwordx4 v162, s[24:27], s83 offen nt lds
    s_add_u32 s83, s83, 294912
    s_add_u32 m0, m0, 4096
    s_nop 0
    buffer_load_dwordx4 v162, s[24:27], s83 offen nt lds
    s_add_u32 s83, s83, 294912
    s_add_u32 m0, m0, 4096
    s_nop 0
    buffer_load_dwordx4 v162, s[24:27], s83 offen nt lds
    s_add_u32 s83, s83, 294912
    s_add_u32 m0, m0, 4096
    s_nop 0
    buffer_load_dwordx4 v162, s[24:27], s83 offen nt lds
    s_add_u32 s83, s83, 294912
    s_add_u32 m0, m0, 4096
    s_waitcnt vmcnt(8)
    s_branch L_no29b
L_no29r1:
    s_cmp_lg_u32 s73, 2
    s_cbranch_scc1 L_no29r2
    s_waitcnt vmcnt(2)
    s_branch L_no29b
L_no29r2:
    s_waitcnt vmcnt(2)
L_no29b:
    s_cmp_lt_u32 s73, 2
    s_cbranch_scc1 L_no29e
    s_mul_i32 s83, s4, 589824
    s_add_u32 s83, s83, 294912
    s_add_u32 s28, s40, s83
    s_addc_u32 s29, s41, 0
    s_mov_b32 s30, 294912
    s_lshl2_add_u32 s83, s5, s3
    s_sub_u32 s83, s83, 72
    s_mul_i32 s83, s83, 5376
    v_lshlrev_b32 v12, 7, v1
    s_bfm_b64 exec, 42, 0
    buffer_load_dword v192, v12, s[28:31], s83 offen
    s_mov_b64 exec, -1
L_no29e:
    s_waitcnt lgkmcnt(0)
    s_barrier
    s_mov_b64 exec, s[56:57]
    ds_read_b128 v[60:63], v169 offset:512
    s_mov_b64 exec, s[58:59]
    ds_read_b128 v[64:67], v169 offset:768
    s_mov_b64 exec, s[60:61]
    ds_read_b128 v[68:71], v169 offset:1024
    s_mov_b64 exec, s[62:63]
    ds_read_b128 v[72:75], v169 offset:1280
    s_mov_b64 exec, -1
    v_mov_b32 v8, 162816
    ds_read_b128 v[124:127], v8
    ds_read_b128 v[128:131], v8 offset:16
    ds_read_b64 v[132:133], v171
    ds_read_b64_tr_b16 a[68:69], v154 offset:8192
    ds_read_b64_tr_b16 a[70:71], v154 offset:8704
    ds_read_b64_tr_b16 a[76:77], v155 offset:8192
    ds_read_b64_tr_b16 a[78:79], v155 offset:8704
    ds_read_b64_tr_b16 a[84:85], v154 offset:24576
    ds_read_b64_tr_b16 a[86:87], v154 offset:25088
    ds_read_b64_tr_b16 a[92:93], v155 offset:24576
    ds_read_b64_tr_b16 a[94:95], v155 offset:25088
    s_waitcnt lgkmcnt(4)
    ds_read_b64_tr_b16 a[100:101], v154 offset:40960
    ds_read_b64_tr_b16 a[102:103], v154 offset:41472
    ds_read_b64_tr_b16 a[108:109], v155 offset:40960
    ds_read_b64_tr_b16 a[110:111], v155 offset:41472
    ds_read_b64_tr_b16 a[116:117], v154 offset:57344
    ds_read_b64_tr_b16 a[118:119], v154 offset:57856
    ds_read_b64_tr_b16 a[124:125], v155 offset:57344
    ds_read_b64_tr_b16 a[126:127], v155 offset:57856
    v_smfmac_f32_16x16x64_bf16 v[116:119], v[60:63], a[64:71], v174
    v_smfmac_f32_16x16x64_bf16 v[120:123], v[60:63], a[72:79], v174
    s_waitcnt lgkmcnt(8)
    v_smfmac_f32_16x16x64_bf16 v[116:119], v[64:67], a[80:87], v174
    v_smfmac_f32_16x16x64_bf16 v[120:123], v[64:67], a[88:95], v174
    s_waitcnt lgkmcnt(4)
    v_smfmac_f32_16x16x64_bf16 v[116:119], v[68:71], a[96:103], v174
    v_smfmac_f32_16x16x64_bf16 v[120:123], v[68:71], a[104:111], v174
    s_waitcnt lgkmcnt(0)
    v_smfmac_f32_16x16x64_bf16 v[116:119], v[72:75], a[112:119], v174
    v_smfmac_f32_16x16x64_bf16 v[120:123], v[72:75], a[120:127], v174
    buffer_load_dwordx2 v[150:151], v184, s[8:11], s87 offen sc1
    s_branch L_pj30
L_o1:
    s_mul_i32 s83, s3, 9216
    s_lshl_b32 s84, s3, 10
    s_add_u32 m0, s84, 102400
    s_add_u32 s83, s83, 331776
    buffer_load_dwordx4 v202, s[20:23], s83 offen nt lds
    s_add_u32 s83, s83, 36864
    s_add_u32 m0, m0, 4096
    s_nop 0
    buffer_load_dwordx4 v202, s[20:23], s83 offen nt lds
    s_add_u32 s83, s83, 36864
    s_add_u32 m0, m0, 4096
    s_nop 0
    buffer_load_dwordx4 v202, s[20:23], s83 offen nt lds
    v_mov_b32 v12, v152
    v_mov_b32 v13, v153
    s_nop 0
    v_min_u32_dpp v12, v12, v12 row_ror:1 row_mask:0xf bank_mask:0xf
    v_min_u32_dpp v13, v13, v13 row_ror:1 row_mask:0xf bank_mask:0xf
    s_nop 0
    v_min_u32_dpp v12, v12, v12 row_ror:2 row_mask:0xf bank_mask:0xf
    v_min_u32_dpp v13, v13, v13 row_ror:2 row_mask:0xf bank_mask:0xf
    s_nop 0
    v_min_u32_dpp v12, v12, v12 row_ror:4 row_mask:0xf bank_mask:0xf
    v_min_u32_dpp v13, v13, v13 row_ror:4 row_mask:0xf bank_mask:0xf
    s_nop 0
    v_min_u32_dpp v12, v12, v12 row_ror:8 row_mask:0xf bank_mask:0xf
    v_min_u32_dpp v13, v13, v13 row_ror:8 row_mask:0xf bank_mask:0xf
    s_nop 0
    v_min_u32_dpp v12, v12, v12 row_bcast:15 row_mask:0xa bank_mask:0xf
    v_min_u32_dpp v13, v13, v13 row_bcast:15 row_mask:0xa bank_mask:0xf
    s_nop 0
    v_min_u32_dpp v12, v12, v12 row_bcast:31 row_mask:0xc bank_mask:0xf
    v_min_u32_dpp v13, v13, v13 row_bcast:31 row_mask:0xc bank_mask:0xf
    v_readlane_b32 s83, v12, 63
    v_readlane_b32 s84, v13, 63
    s_cmp_lt_u32 s84, s83
    s_cselect_b32 s91, 8192, 0
    s_lshl_b32 s97, s4, 11
    s_and_b32 s97, s97, 8192
    s_xor_b32 s97, s97, s91
    s_xor_b32 s98, s97, 8192
    s_add_u32 s97, s97, s90
    s_add_u32 s98, s98, s90
    s_mul_i32 s83, s3, 9216
    s_lshl_b32 s84, s3, 10
    s_add_u32 m0, s84, 114688
    s_add_u32 s83, s83, 442368
    buffer_load_dwordx4 v202, s[20:23], s83 offen nt lds
    s_add_u32 s83, s83, 36864
    s_add_u32 m0, m0, 4096
    s_nop 0
    buffer_load_dwordx4 v202, s[20:23], s83 offen nt lds
    s_add_u32 s83, s83, 36864
    s_add_u32 m0, m0, 4096
    s_nop 0
    buffer_load_dwordx4 v202, s[20:23], s83 offen nt lds
    s_add_u32 s83, s83, 36864
    s_add_u32 m0, m0, 4096
    s_nop 0
    buffer_load_dwordx4 v202, s[20:23], s83 offen nt lds
    s_waitcnt vmcnt(7)
    v_max_u32 v4, v150, v151
    v_cmp_eq_u32 vcc, -1, v4
    s_cbranch_vccnz L_o1d
    v_mov_b32 v10, v150
    v_mov_b32 v11, v151
    s_nop 0
    v_max_f32_dpp v8, v10, v10 quad_perm:[1,0,3,2] row_mask:0xf bank_mask:0xf
    s_nop 1
    v_max_f32_dpp v8, v8, v8 quad_perm:[2,3,0,1] row_mask:0xf bank_mask:0xf
    s_nop 1
    v_max_f32_dpp v9, v8, v8 row_ror:4 row_mask:0xf bank_mask:0xf
    s_nop 1
    v_max_f32_dpp v9, v9, v9 row_ror:8 row_mask:0xf bank_mask:0xf
    s_nop 1
    v_max_f32_dpp v9, v9, v9 row_bcast:15 row_mask:0xa bank_mask:0xf
    s_nop 1
    v_max_f32_dpp v9, v9, v9 row_bcast:31 row_mask:0xc bank_mask:0xf
    s_nop 0
    v_readlane_b32 s83, v9, 63
    s_nop 1
    v_subrev_f32 v10, s83, v10
    v_subrev_f32 v8, s83, v8
    v_exp_f32 v10, v10
    v_exp_f32 v8, v8
    v_mul_f32 v11, v10, v11
    s_nop 1
    v_add_f32_dpp v11, v11, v11 row_ror:1 row_mask:0xf bank_mask:0xf
    s_nop 1
    v_add_f32_dpp v11, v11, v11 row_ror:2 row_mask:0xf bank_mask:0xf
    s_nop 1
    v_add_f32_dpp v11, v11, v11 row_ror:4 row_mask:0xf bank_mask:0xf
    s_nop 1
    v_add_f32_dpp v11, v11, v11 row_ror:8 row_mask:0xf bank_mask:0xf
    s_nop 1
    v_add_f32_dpp v11, v11, v11 row_bcast:15 row_mask:0xa bank_mask:0xf
    s_nop 1
    v_add_f32_dpp v11, v11, v11 row_bcast:31 row_mask:0xc bank_mask:0xf
    s_nop 0
    v_readlane_b32 s83, v11, 63
    s_nop 1
    v_rcp_f32 v11, s83
    s_nop 0
    v_mul_f32 v8, v8, v11
    v_cvt_pk_bf16_f32 v8, v8, v8
    s_nop 1
    v_and_b32_dpp v108, v8, v176 row_newbcast:0 row_mask:0xf bank_mask:0xf
    v_and_b32_dpp v109, v8, v177 row_newbcast:0 row_mask:0xf bank_mask:0xf
    v_and_b32_dpp v110, v8, v176 row_newbcast:4 row_mask:0xf bank_mask:0xf
    v_and_b32_dpp v111, v8, v177 row_newbcast:4 row_mask:0xf bank_mask:0xf
    v_and_b32_dpp v112, v8, v176 row_newbcast:8 row_mask:0xf bank_mask:0xf
    v_and_b32_dpp v113, v8, v177 row_newbcast:8 row_mask:0xf bank_mask:0xf
    v_and_b32_dpp v114, v8, v176 row_newbcast:12 row_mask:0xf bank_mask:0xf
    v_and_b32_dpp v115, v8, v177 row_newbcast:12 row_mask:0xf bank_mask:0xf
    s_waitcnt vmcnt(2)
    buffer_load_dwordx4 v[92:95], v183, s[8:11], s87 offen offset:0 sc1
    buffer_load_dwordx4 v[96:99], v183, s[8:11], s87 offen offset:1024 sc1
    buffer_load_dwordx4 v[100:103], v183, s[8:11], s87 offen offset:2048 sc1
    buffer_load_dwordx4 v[104:107], v183, s[8:11], s87 offen offset:3072 sc1
    s_waitcnt vmcnt(4)
    s_barrier
    ds_read_b64_tr_b16 a[152:153], v163 offset:0
    ds_read_b64_tr_b16 a[154:155], v163 offset:256
    ds_read_b64_tr_b16 a[156:157], v163 offset:4096
    ds_read_b64_tr_b16 a[158:159], v163 offset:4352
    ds_read_b64_tr_b16 a[160:161], v163 offset:8192
    ds_read_b64_tr_b16 a[162:163], v163 offset:8448
    ds_read_b64_tr_b16 a[164:165], v163 offset:12288
    ds_read_b64_tr_b16 a[166:167], v163 offset:12544
    ds_read_b64_tr_b16 a[168:169], v163 offset:16384
    ds_read_b64_tr_b16 a[170:171], v163 offset:16640
    ds_read_b64_tr_b16 a[172:173], v163 offset:20480
    ds_read_b64_tr_b16 a[174:175], v163 offset:20736
    ds_read_b64_tr_b16 a[176:177], v163 offset:24576
    ds_read_b64_tr_b16 a[178:179], v163 offset:24832
    ds_read_b64_tr_b16 a[180:181], v163 offset:28672
    ds_read_b64_tr_b16 a[182:183], v163 offset:28928
    ds_read_b64_tr_b16 a[184:185], v163 offset:32768
    ds_read_b64_tr_b16 a[186:187], v163 offset:33024
    ds_read_b64_tr_b16 a[188:189], v163 offset:36864
    ds_read_b64_tr_b16 a[190:191], v163 offset:37120
    ds_read_b64_tr_b16 a[192:193], v163 offset:40960
    ds_read_b64_tr_b16 a[194:195], v163 offset:41216
    ds_read_b64_tr_b16 a[196:197], v163 offset:45056
    ds_read_b64_tr_b16 a[198:199], v163 offset:45312
    ds_read_b64_tr_b16 a[200:201], v163 offset:49152
    ds_read_b64_tr_b16 a[202:203], v163 offset:49408
    ds_read_b64_tr_b16 a[204:205], v163 offset:53248
    ds_read_b64_tr_b16 a[206:207], v163 offset:53504
    ds_read_b64_tr_b16 a[208:209], v163 offset:57344
    ds_read_b64_tr_b16 a[210:211], v163 offset:57600
    ds_read_b64_tr_b16 a[212:213], v163 offset:61440
    ds_read_b64_tr_b16 a[214:215], v163 offset:61696
    s_waitcnt vmcnt(0)
    v_max3_u32 v4, v92, v96, v100
    v_max3_u32 v4, v4, v104, v104
    v_cmp_eq_u32 vcc, -1, v4
    s_waitcnt lgkmcnt(0)
    s_cbranch_vccz L_oa
    buffer_load_dwordx4 v[92:95], v183, s[8:11], s87 offen offset:0 sc1
    buffer_load_dwordx4 v[96:99], v183, s[8:11], s87 offen offset:1024 sc1
    buffer_load_dwordx4 v[100:103], v183, s[8:11], s87 offen offset:2048 sc1
    buffer_load_dwordx4 v[104:107], v183, s[8:11], s87 offen offset:3072 sc1
    s_branch L_oloop
L_o1d:
    s_waitcnt vmcnt(0)
    s_barrier
    ds_read_b64_tr_b16 a[152:153], v163 offset:0
    ds_read_b64_tr_b16 a[154:155], v163 offset:256
    ds_read_b64_tr_b16 a[156:157], v163 offset:4096
    ds_read_b64_tr_b16 a[158:159], v163 offset:4352
    ds_read_b64_tr_b16 a[160:161], v163 offset:8192
    ds_read_b64_tr_b16 a[162:163], v163 offset:8448
    ds_read_b64_tr_b16 a[164:165], v163 offset:12288
    ds_read_b64_tr_b16 a[166:167], v163 offset:12544
    ds_read_b64_tr_b16 a[168:169], v163 offset:16384
    ds_read_b64_tr_b16 a[170:171], v163 offset:16640
    ds_read_b64_tr_b16 a[172:173], v163 offset:20480
    ds_read_b64_tr_b16 a[174:175], v163 offset:20736
    ds_read_b64_tr_b16 a[176:177], v163 offset:24576
    ds_read_b64_tr_b16 a[178:179], v163 offset:24832
    ds_read_b64_tr_b16 a[180:181], v163 offset:28672
    ds_read_b64_tr_b16 a[182:183], v163 offset:28928
    ds_read_b64_tr_b16 a[184:185], v163 offset:32768
    ds_read_b64_tr_b16 a[186:187], v163 offset:33024
    ds_read_b64_tr_b16 a[188:189], v163 offset:36864
    ds_read_b64_tr_b16 a[190:191], v163 offset:37120
    ds_read_b64_tr_b16 a[192:193], v163 offset:40960
    ds_read_b64_tr_b16 a[194:195], v163 offset:41216
    ds_read_b64_tr_b16 a[196:197], v163 offset:45056
    ds_read_b64_tr_b16 a[198:199], v163 offset:45312
    ds_read_b64_tr_b16 a[200:201], v163 offset:49152
    ds_read_b64_tr_b16 a[202:203], v163 offset:49408
    ds_read_b64_tr_b16 a[204:205], v163 offset:53248
    ds_read_b64_tr_b16 a[206:207], v163 offset:53504
    ds_read_b64_tr_b16 a[208:209], v163 offset:57344
    ds_read_b64_tr_b16 a[210:211], v163 offset:57600
    ds_read_b64_tr_b16 a[212:213], v163 offset:61440
    ds_read_b64_tr_b16 a[214:215], v163 offset:61696
    s_waitcnt lgkmcnt(0)
    s_branch L_o1b
L_oretry:
    buffer_load_dwordx4 v[92:95], v183, s[8:11], s87 offen offset:0 sc1
    buffer_load_dwordx4 v[96:99], v183, s[8:11], s87 offen offset:1024 sc1
    buffer_load_dwordx4 v[100:103], v183, s[8:11], s87 offen offset:2048 sc1
    buffer_load_dwordx4 v[104:107], v183, s[8:11], s87 offen offset:3072 sc1
    s_sub_u32 s80, s80, 1
    s_cbranch_scc0 L_oloop
    s_mov_b32 s80, 0
    s_waitcnt vmcnt(0)
    s_branch L_oa
L_xt7:
    s_mov_b32 s80, 0
    s_waitcnt vmcnt(0)
    s_branch L_xa5
L_her18:
    s_mov_b32 s80, 0
    s_waitcnt vmcnt(0)
    s_branch L_hed17
L_h2r22:
    s_mov_b32 s80, 0
    s_waitcnt vmcnt(0)
    s_branch L_h2d21
L_hqr27:
    s_mov_b32 s80, 0
    s_waitcnt vmcnt(0)
    s_branch L_hqd26
L_h1t12:
    s_mov_b32 s80, 0
    s_waitcnt vmcnt(0)
    s_branch L_h1a10
L_other:
    s_cmp_eq_u32 s73, 2
    s_cbranch_scc1 L_f2
    s_cmp_eq_u32 s73, 1
    s_cbranch_scc1 L_f1
    s_branch L_idle
L_met35:
    s_mov_b32 s80, 0
    s_waitcnt vmcnt(0)
    s_branch L_mea33
L_rt41:
    s_mov_b32 s80, 0
    s_waitcnt vmcnt(0)
    s_branch L_ra39
L_rt50:
    s_mov_b32 s80, 0
    s_waitcnt vmcnt(0)
    s_branch L_ra48
L_x1t61:
    s_mov_b32 s80, 0
    s_waitcnt vmcnt(0)
    s_branch L_x1a59
L_act72:
    s_mov_b32 s80, 0
    s_waitcnt vmcnt(0)
    s_branch L_aca70
L_exit:
L_end:
    s_endpgm
.section .rodata,"a"
.p2align 6
.amdhsa_kernel interleave_layers__sliding_block_cached__dense_activation_mish__decode_kernel
  .amdhsa_next_free_vgpr 428
  .amdhsa_next_free_sgpr 102
  .amdhsa_accum_offset 204
  .amdhsa_group_segment_fixed_size 0
  .amdhsa_kernarg_size 96
  .amdhsa_user_sgpr_count 2
  .amdhsa_user_sgpr_kernarg_segment_ptr 1
  .amdhsa_system_sgpr_workgroup_id_x 1
.end_amdhsa_kernel
```
